```python
import torch

def _softmax(x, axis=-1):
    return torch.softmax(x, dim=axis)
def _gelu(x):
    return torch.nn.functional.gelu(x, approximate="tanh")
def _silu(x):
    return torch.nn.functional.silu(x)
def _sigmoid(x):
    return torch.sigmoid(x)
def _layernorm(x, axis=-1, eps=1e-5):
    m = x.mean(dim=axis, keepdim=True)
    v = x.var(dim=axis, keepdim=True, unbiased=False)
    return (x - m) / torch.sqrt(v + eps)
def _scatter_add(tgt, idx, src, axis=0):
    return tgt.clone().index_add_(axis, idx, src)
def _segment_sum(src, seg, n):
    out = torch.zeros((n,) + src.shape[1:], dtype=src.dtype)
    return out.index_add_(0, seg, src)
def _pad(x, pw):
    flat = tuple(v for pair in reversed(pw) for v in pair)
    return torch.nn.functional.pad(x, flat)

kernel_name = 'gated_mix__mha_block__mixer_token_mlp__prompt'

def setup_inputs():

    _w = (lambda a: (lambda t: t.to(torch.bfloat16) if t.is_floating_point() else t)(torch.as_tensor(a)))
    def _A_setup():
        B, S, D, H = 1, 2048, 640, 32
        return {
            "x": _w((lambda *s: torch.randn(*s, dtype=torch.bfloat16) * 0.05)(B, S, D)),
            "wqkv": _w((lambda *s: torch.randn(*s, dtype=torch.bfloat16) * 0.8)(D, 3 * D)),
            "wo": _w((lambda *s: torch.randn(*s, dtype=torch.bfloat16) * 0.05)(D, D)),
        }
    _A_in = _A_setup()

    def _B_setup():
        B, S, D, F = 1, 2048, 640, 1536
        return {
            "x": _w((lambda *s: torch.randn(*s, dtype=torch.bfloat16) * 0.05)(B, S, D)),
            "w1": _w((lambda *s: torch.randn(*s, dtype=torch.bfloat16) * 0.8)(S, F) * (S ** -0.5)),
            "b1": _w((lambda *s: torch.randn(*s, dtype=torch.bfloat16) * 12.8)(F) * 0.02),
            "w2": _w((lambda *s: torch.randn(*s, dtype=torch.bfloat16) * 0.1)(F, S) * (F ** -0.5)),
            "b2": _w((lambda *s: torch.randn(*s, dtype=torch.bfloat16) * 0.8)(S) * 0.02),
        }
    _B_in = _B_setup()

    return {
        "A_x": _A_in["x"],
        "A_wqkv": _A_in["wqkv"],
        "A_wo": _A_in["wo"],
        "B_x": _B_in["x"],
        "B_w1": _B_in["w1"],
        "B_b1": _B_in["b1"],
        "B_w2": _B_in["w2"],
        "B_b2": _B_in["b2"],
        "gate_w": _w((lambda *s: torch.randn(*s, dtype=torch.bfloat16) * 0.05)(640) * 16.0),
    }

def reference(A_x, A_wqkv, A_wo, B_x, B_w1, B_b1, B_w2, B_b2, gate_w):
    def _A_ref(x, wqkv, wo):
        B, S, D = x.shape
        H = 32
        Dh = D // H
        qkv = (lambda x, *d: x.permute(*d))((x @ wqkv).reshape(B, S, 3, H, Dh), 2, 0, 3, 1, 4)
        q, k, v = qkv[0], qkv[1], qkv[2]
        scores = torch.einsum("bhqd,bhkd->bhqk", q, k) * (Dh ** -0.5)
        p = _softmax(scores, axis=-1)
        o = torch.einsum("bhqk,bhkd->bhqd", p, v)
        return (lambda x, *d: x.permute(*d))(o, 0, 2, 1, 3).reshape(B, S, D) @ wo

    def _B_ref(x, w1, b1, w2, b2):
        B, S, D = x.shape
        h = _layernorm(x, axis=-1)
        u = torch.einsum("bsd,sf->bdf", h, w1) + b1
        u = _gelu(u)
        y = torch.einsum("bdf,fs->bds", u, w2) + b2
        return (lambda x, *d: x.permute(*d))(y, 0, 2, 1)

    x = A_x
    g = _sigmoid((x * gate_w).sum(-1, keepdims=True))
    a = _A_ref(x, A_wqkv, A_wo)
    b = _B_ref(x, B_w1, B_b1, B_w2, B_b2)
    return g * a + (1 - g) * b
```

```asm
; @launch grid=(256,1,1) block=(768,1,1) lds=163840
.amdgcn_target "amdgcn-amd-amdhsa--gfx950"
.text
code_begin:
.globl gated_mix__mha_block__mixer_token_mlp__prompt_kernel
.p2align 8
.type gated_mix__mha_block__mixer_token_mlp__prompt_kernel,@function
gated_mix__mha_block__mixer_token_mlp__prompt_kernel:
    s_getpc_b64 s[50:51]
    v_and_b32 v1, 63, v0
    v_lshlrev_b32 v1, 7, v1
    global_load_dword v167, v1, s[50:51]
    s_load_dwordx2 s[4:5], s[0:1], 0
    s_load_dwordx2 s[8:9], s[0:1], 8
    s_load_dwordx2 s[40:41], s[0:1], 64
    s_cmp_ge_u32 s2, 256
    s_cbranch_scc1 gated_mix__mha_block__mixer_token_mlp__prompt_kernel_exit
    v_lshrrev_b32 v1, 6, v0
    s_lshr_b32 s44, s2, 3
    v_readfirstlane_b32 s42, v1
    s_mov_b32 s6, 2621440
    s_mov_b32 s7, 0x00020000
    s_mov_b32 s10, 2457600
    s_mov_b32 s11, s7
    s_bfe_u32 s46, s2, 0x20001
    s_and_b32 s49, s2, 1
    s_lshl2_add_u32 s43, s49, s46
    s_and_b32 s48, s44, 3
    s_lshl2_add_u32 s46, s46, s48
    s_lshr_b32 s48, s44, 2
    s_lshl3_add_u32 s47, s49, s48
    s_cmp_lt_u32 s42, 8
    s_cbranch_scc1 gated_mix__mha_block__mixer_token_mlp__prompt_kernel_p1
    s_setprio 3
    s_sub_u32 s48, s42, 8
    v_and_b32 v0, 63, v0
    s_and_b32 s67, s43, 3
    s_lshl1_add_u32 s67, s67, s49
    s_lshl_b32 s67, s67, 5
    s_add_u32 s67, s67, s44
    s_lshl2_add_u32 s68, s67, s48
    s_lshl_b32 s68, s68, 1
    s_mul_i32 s69, s68, 1280
    v_and_b32 v1, 31, v0
    v_lshrrev_b32 v3, 5, v0
    v_lshlrev_b32 v2, 3, v1
    v_lshlrev_b32 v1, 4, v1
    v_mul_u32_u24 v19, 1280, v3
    v_add_u32 v18, v19, v1
    v_add_u32 v19, v19, v2
    s_waitcnt lgkmcnt(0)
    buffer_load_dwordx4 v[8:11], v18, s[4:7], s69 offen
    buffer_load_dwordx4 v[12:15], v18, s[4:7], s69 offen offset:512
    buffer_load_dwordx2 v[16:17], v19, s[4:7], s69 offen offset:1024
    global_load_dwordx4 v[20:23], v1, s[40:41]
    global_load_dwordx4 v[24:27], v1, s[40:41] offset:512
    global_load_dwordx2 v[28:29], v2, s[40:41] offset:1024
    s_branch gated_mix__mha_block__mixer_token_mlp__prompt_kernel_grole
gated_mix__mha_block__mixer_token_mlp__prompt_kernel_p1:
    s_cmp_eq_u32 s47, 15
    s_cbranch_scc1 gated_mix__mha_block__mixer_token_mlp__prompt_kernel_idle
    s_cmp_lt_u32 s42, 4
    s_cbranch_scc1 gated_mix__mha_block__mixer_token_mlp__prompt_kernel_qkv_comp
    v_and_b32 v0, 63, v0
    s_and_b32 s53, s46, 3
    s_mul_i32 s53, s53, 5
    s_lshl1_add_u32 s53, s48, s53
    s_lshr_b32 s54, s46, 2
    s_add_u32 s53, s53, s54
    s_lshr_b32 s53, s53, 1
    s_cmp_ge_u32 s53, 10
    s_cselect_b32 s54, 10, 0
    s_sub_u32 s53, s53, s54
    s_sub_u32 s48, s42, 4
    s_lshl_b32 s49, s48, 4
    v_lshrrev_b32 v33, 4, v0
    v_add_u32 v32, s49, v33
    v_mul_u32_u24 v32, 3840, v32
    v_lshlrev_b32 v35, 2, v33
    v_and_b32 v34, 15, v0
    v_xor_b32 v34, v34, v35
    v_lshl_add_u32 v43, v34, 4, v32
    s_movk_i32 s54, 14336
    v_add_u32 v44, s54, v43
    v_xor_b32 v45, 32, v44
    v_add_u32 v45, s54, v45
    v_add_u32 v46, s54, v45
    s_lshl_b32 s51, s47, 8
    s_lshl_b32 s52, s48, 12
    s_waitcnt lgkmcnt(0)
    s_mul_i32 s54, s53, 245760
    s_add_u32 m0, s52, 16384
    s_add_u32 s54, s54, s51
    buffer_load_dwordx4 v43, s[8:11], s54 offen offset:0 lds
    buffer_load_dwordx4 v44, s[8:11], s54 offen offset:1024 lds
    buffer_load_dwordx4 v45, s[8:11], s54 offen offset:2048 lds
    buffer_load_dwordx4 v46, s[8:11], s54 offen offset:3072 lds
    v_lshrrev_b32 v32, 3, v0
    s_lshl_b32 s54, s48, 5
    v_add_u32 v32, s54, v32
    v_mul_u32_u24 v32, 1280, v32
    v_and_b32 v35, 7, v0
    v_xor_b32 v35, v35, v33
    v_lshl_add_u32 v39, v35, 4, v32
    s_movk_i32 s54, 9216
    v_xor_b32 v40, 64, v39
    v_add_u32 v40, s54, v40
    s_lshl_b32 s54, s54, 1
    v_add_u32 v41, s54, v39
    v_add_u32 v42, s54, v40
    s_mul_i32 s50, s46, 163840
    s_lshl_b32 s54, s53, 7
    s_add_u32 m0, s52, 0
    s_add_u32 s54, s54, s50
    buffer_load_dwordx4 v39, s[4:7], s54 offen offset:0 lds
    buffer_load_dwordx4 v40, s[4:7], s54 offen offset:1024 lds
    buffer_load_dwordx4 v41, s[4:7], s54 offen offset:2048 lds
    buffer_load_dwordx4 v42, s[4:7], s54 offen offset:3072 lds
    s_add_u32 s53, s53, 1
    s_cmp_eq_u32 s53, 10
    s_cselect_b32 s53, 0, s53
    s_branch gated_mix__mha_block__mixer_token_mlp__prompt_kernel_over2
gated_mix__mha_block__mixer_token_mlp__prompt_kernel_grole:
    s_load_dwordx2 s[24:25], s[0:1], 88
    s_load_dwordx2 s[32:33], s[0:1], 80
    s_load_dwordx2 s[16:17], s[0:1], 32
    s_load_dwordx2 s[20:21], s[0:1], 48
    s_load_dwordx2 s[12:13], s[0:1], 16
    s_load_dwordx2 s[28:29], s[0:1], 72
    s_load_dwordx2 s[36:37], s[0:1], 40
    s_load_dwordx2 s[38:39], s[0:1], 56
    s_mov_b32 s14, 819200
    s_mov_b32 s15, s7
    s_mov_b32 s18, 6291456
    s_mov_b32 s19, s7
    s_mov_b32 s22, s18
    s_mov_b32 s23, s7
    s_mov_b32 s26, 25165824
    s_mov_b32 s27, s7
    s_mov_b32 s30, s6
    s_mov_b32 s31, s7
    s_mov_b32 s34, 256
    s_mov_b32 s35, s7
    s_lshr_b32 s3, s43, 2
    s_lshl_b32 s3, s3, 5
    s_add_u32 s3, s3, s44
    s_min_u32 s3, s3, 59
    s_mul_i32 s101, s3, 52
    s_lshr_b32 s101, s101, 8
    s_mul_i32 s100, s101, 5
    s_sub_u32 s100, s3, s100
    s_waitcnt lgkmcnt(0)
    v_lshlrev_b32 v1, 2, v0
    v_add_u32 v1, 163584, v1
    v_mov_b32 v2, 0
    ds_write_b32 v1, v2
    s_mov_b32 s70, 0x3f803f80
    s_lshl_b32 s55, s68, 2
    s_add_u32 s55, s55, 15204352
    s_add_u32 s69, s69, 7864320
    v_lshlrev_b32 v3, 2, v3
    v_and_b32 v30, 15, v0
    v_lshlrev_b32 v30, 2, v30
    s_waitcnt vmcnt(0)
    v_dot2_f32_bf16 v4, v8, s70, 0
    v_dot2_f32_bf16 v5, v8, v20, 0
    v_dot2_f32_bf16 v4, v9, s70, v4
    v_dot2_f32_bf16 v5, v9, v21, v5
    v_dot2_f32_bf16 v4, v10, s70, v4
    v_dot2_f32_bf16 v5, v10, v22, v5
    v_dot2_f32_bf16 v4, v11, s70, v4
    v_dot2_f32_bf16 v5, v11, v23, v5
    v_dot2_f32_bf16 v4, v12, s70, v4
    v_dot2_f32_bf16 v5, v12, v24, v5
    v_dot2_f32_bf16 v4, v13, s70, v4
    v_dot2_f32_bf16 v5, v13, v25, v5
    v_dot2_f32_bf16 v4, v14, s70, v4
    v_dot2_f32_bf16 v5, v14, v26, v5
    v_dot2_f32_bf16 v4, v15, s70, v4
    v_dot2_f32_bf16 v5, v15, v27, v5
    v_dot2_f32_bf16 v4, v16, s70, v4
    v_dot2_f32_bf16 v5, v16, v28, v5
    v_dot2_f32_bf16 v4, v17, s70, v4
    v_dot2_f32_bf16 v5, v17, v29, v5
    v_lshlrev_b32 v32, 16, v8
    v_and_b32 v33, 0xffff0000, v8
    v_lshlrev_b32 v34, 16, v9
    v_add_f32_dpp v4, v4, v4 row_ror:8 row_mask:0xf bank_mask:0xf
    v_add_f32_dpp v5, v5, v5 row_ror:8 row_mask:0xf bank_mask:0xf
    v_and_b32 v35, 0xffff0000, v9
    v_add_f32_dpp v4, v4, v4 row_ror:4 row_mask:0xf bank_mask:0xf
    v_add_f32_dpp v5, v5, v5 row_ror:4 row_mask:0xf bank_mask:0xf
    v_lshlrev_b32 v36, 16, v10
    v_add_f32_dpp v4, v4, v4 row_ror:2 row_mask:0xf bank_mask:0xf
    v_add_f32_dpp v5, v5, v5 row_ror:2 row_mask:0xf bank_mask:0xf
    v_and_b32 v37, 0xffff0000, v10
    v_add_f32_dpp v4, v4, v4 row_ror:1 row_mask:0xf bank_mask:0xf
    v_add_f32_dpp v5, v5, v5 row_ror:1 row_mask:0xf bank_mask:0xf
    v_lshlrev_b32 v38, 16, v11
    v_mov_b32 v6, v4
    v_mov_b32 v7, v5
    v_and_b32 v39, 0xffff0000, v11
    v_lshlrev_b32 v40, 16, v12
    v_permlane16_swap_b32 v4, v6
    v_permlane16_swap_b32 v5, v7
    v_and_b32 v41, 0xffff0000, v12
    v_lshlrev_b32 v42, 16, v13
    v_add_f32 v4, v4, v6
    v_add_f32 v5, v5, v7
    v_mul_f32 v4, 0xbacccccd, v4
    v_mul_f32 v5, 0xbfb8aa3b, v5
    v_exp_f32 v5, v5
    v_and_b32 v43, 0xffff0000, v13
    v_lshlrev_b32 v44, 16, v14
    v_and_b32 v45, 0xffff0000, v14
    v_lshlrev_b32 v46, 16, v15
    v_and_b32 v47, 0xffff0000, v15
    v_lshlrev_b32 v48, 16, v16
    v_and_b32 v49, 0xffff0000, v16
    v_lshlrev_b32 v50, 16, v17
    v_and_b32 v51, 0xffff0000, v17
    v_add_f32 v5, 1.0, v5
    v_rcp_f32 v2, v5
    v_pk_add_f32 v[32:33], v[32:33], v[4:5] op_sel_hi:[1,0]
    v_pk_add_f32 v[34:35], v[34:35], v[4:5] op_sel_hi:[1,0]
    v_pk_add_f32 v[36:37], v[36:37], v[4:5] op_sel_hi:[1,0]
    v_pk_add_f32 v[38:39], v[38:39], v[4:5] op_sel_hi:[1,0]
    v_pk_add_f32 v[40:41], v[40:41], v[4:5] op_sel_hi:[1,0]
    v_pk_add_f32 v[42:43], v[42:43], v[4:5] op_sel_hi:[1,0]
    v_pk_add_f32 v[44:45], v[44:45], v[4:5] op_sel_hi:[1,0]
    v_pk_add_f32 v[46:47], v[46:47], v[4:5] op_sel_hi:[1,0]
    v_pk_add_f32 v[48:49], v[48:49], v[4:5] op_sel_hi:[1,0]
    v_pk_add_f32 v[50:51], v[50:51], v[4:5] op_sel_hi:[1,0]
    v_pk_mul_f32 v[6:7], v[32:33], v[32:33]
    v_pk_mul_f32 v[52:53], v[34:35], v[34:35]
    v_pk_fma_f32 v[6:7], v[36:37], v[36:37], v[6:7]
    v_pk_fma_f32 v[52:53], v[38:39], v[38:39], v[52:53]
    v_pk_fma_f32 v[6:7], v[40:41], v[40:41], v[6:7]
    v_pk_fma_f32 v[52:53], v[42:43], v[42:43], v[52:53]
    v_pk_fma_f32 v[6:7], v[44:45], v[44:45], v[6:7]
    v_pk_fma_f32 v[52:53], v[46:47], v[46:47], v[52:53]
    v_pk_fma_f32 v[6:7], v[48:49], v[48:49], v[6:7]
    v_pk_fma_f32 v[52:53], v[50:51], v[50:51], v[52:53]
    v_pk_add_f32 v[6:7], v[6:7], v[52:53]
    v_add_f32 v6, v6, v7
    s_nop 1
    v_add_f32_dpp v6, v6, v6 row_ror:8 row_mask:0xf bank_mask:0xf
    s_nop 1
    v_add_f32_dpp v6, v6, v6 row_ror:4 row_mask:0xf bank_mask:0xf
    s_nop 1
    v_add_f32_dpp v6, v6, v6 row_ror:2 row_mask:0xf bank_mask:0xf
    s_nop 1
    v_add_f32_dpp v6, v6, v6 row_ror:1 row_mask:0xf bank_mask:0xf
    v_mov_b32 v7, v6
    v_mov_b32 v4, 0x3727c5ac
    s_nop 0
    v_permlane16_swap_b32 v6, v7
    s_nop 1
    v_add_f32 v6, v6, v7
    v_fmac_f32 v4, 0x3acccccd, v6
    v_rsq_f32 v4, v4
    s_nop 0
    v_pk_mul_f32 v[32:33], v[32:33], v[4:5] op_sel_hi:[1,0]
    v_pk_mul_f32 v[34:35], v[34:35], v[4:5] op_sel_hi:[1,0]
    v_pk_mul_f32 v[36:37], v[36:37], v[4:5] op_sel_hi:[1,0]
    v_pk_mul_f32 v[38:39], v[38:39], v[4:5] op_sel_hi:[1,0]
    v_pk_mul_f32 v[40:41], v[40:41], v[4:5] op_sel_hi:[1,0]
    v_pk_mul_f32 v[42:43], v[42:43], v[4:5] op_sel_hi:[1,0]
    v_pk_mul_f32 v[44:45], v[44:45], v[4:5] op_sel_hi:[1,0]
    v_pk_mul_f32 v[46:47], v[46:47], v[4:5] op_sel_hi:[1,0]
    v_pk_mul_f32 v[48:49], v[48:49], v[4:5] op_sel_hi:[1,0]
    v_pk_mul_f32 v[50:51], v[50:51], v[4:5] op_sel_hi:[1,0]
    v_cvt_pk_bf16_f32 v8, v32, v33
    v_cvt_pk_bf16_f32 v9, v34, v35
    v_cvt_pk_bf16_f32 v10, v36, v37
    v_cvt_pk_bf16_f32 v11, v38, v39
    v_cvt_pk_bf16_f32 v12, v40, v41
    v_cvt_pk_bf16_f32 v13, v42, v43
    v_cvt_pk_bf16_f32 v14, v44, v45
    v_cvt_pk_bf16_f32 v15, v46, v47
    v_cvt_pk_bf16_f32 v16, v48, v49
    v_cvt_pk_bf16_f32 v17, v50, v51
    s_waitcnt lgkmcnt(0)
    s_barrier
    buffer_store_dwordx4 v[8:11], v18, s[24:27], s69 offen sc1
    buffer_store_dwordx4 v[12:15], v18, s[24:27], s69 offen offset:512 sc1
    buffer_store_dwordx2 v[16:17], v19, s[24:27], s69 offen offset:1024 sc1
    s_mov_b32 exec_lo, 1
    s_mov_b32 exec_hi, 1
    buffer_store_dword v2, v3, s[24:27], s55 offen sc1
    s_mov_b64 exec, -1
    s_cmp_lg_u32 s48, 0
    s_cbranch_scc1 gated_mix__mha_block__mixer_token_mlp__prompt_kernel_g3
    buffer_load_dword v31, v30, s[32:35], 0 offen offset:0 sc1
gated_mix__mha_block__mixer_token_mlp__prompt_kernel_g3:
    s_waitcnt lgkmcnt(0)
    s_barrier
    s_waitcnt vmcnt(0)
    s_barrier
    s_mul_i32 s54, s67, 4
    s_add_u32 s54, s54, 15285248
    s_cmp_lg_u32 s48, 0
    s_cbranch_scc1 gated_mix__mha_block__mixer_token_mlp__prompt_kernel_g4
    s_mov_b32 s45, 200000
    s_waitcnt vmcnt(0)
    s_branch gated_mix__mha_block__mixer_token_mlp__prompt_kernel_pollc7
gated_mix__mha_block__mixer_token_mlp__prompt_kernel_poll5:
    buffer_load_dword v31, v30, s[32:35], 0 offen offset:0 sc1
    s_waitcnt vmcnt(0)
gated_mix__mha_block__mixer_token_mlp__prompt_kernel_pollc7:
    v_cmp_eq_u32 vcc, 0, v31
    s_cbranch_vccz gated_mix__mha_block__mixer_token_mlp__prompt_kernel_polld6
    s_sleep 4
    s_sub_u32 s45, s45, 1
    s_cbranch_scc0 gated_mix__mha_block__mixer_token_mlp__prompt_kernel_poll5
gated_mix__mha_block__mixer_token_mlp__prompt_kernel_polld6:
    s_mov_b64 exec, 1
    v_mov_b32 v4, 0
    v_mov_b32 v5, 1
    buffer_store_dword v5, v4, s[24:27], s54 offen sc1
    s_mov_b64 exec, -1
gated_mix__mha_block__mixer_token_mlp__prompt_kernel_g4:
    s_and_b32 s50, s43, 3
    s_lshl_b32 s51, s101, 2
    s_and_b32 s54, s48, 2
    s_add_u32 s51, s51, s54
    s_lshr_b32 s54, s50, 1
    s_add_u32 s51, s51, s54
    s_lshl_b32 s52, s100, 1
    s_and_b32 s54, s48, 1
    s_add_u32 s52, s52, s54
    s_lshl_b32 s52, s52, 1
    s_and_b32 s54, s50, 1
    s_add_u32 s52, s52, s54
    s_lshl_b32 s62, s43, 2
    s_and_b32 s54, s44, 3
    s_add_u32 s62, s62, s54
    s_lshr_b32 s63, s44, 2
    s_lshl_b32 s66, s62, 6
    s_lshl_b32 s54, s48, 4
    s_add_u32 s66, s66, s54
    s_lshl_b32 s54, s51, 6
    v_lshrrev_b32 v1, 4, v0
    v_lshl_add_u32 v1, v1, 3, s54
    v_and_b32 v2, 15, v0
    v_add_lshl_u32 v2, s66, v2, 1
    global_load_dwordx2 v[54:55], v1, s[36:37] offset:0
    global_load_dwordx2 v[56:57], v1, s[36:37] offset:32
    global_load_ushort v62, v2, s[38:39]
    s_branch gated_mix__mha_block__mixer_token_mlp__prompt_kernel_grole2
gated_mix__mha_block__mixer_token_mlp__prompt_kernel_over2:
    s_load_dwordx2 s[24:25], s[0:1], 88
    s_load_dwordx2 s[32:33], s[0:1], 80
    s_load_dwordx2 s[16:17], s[0:1], 32
    s_load_dwordx2 s[20:21], s[0:1], 48
    s_load_dwordx2 s[12:13], s[0:1], 16
    s_load_dwordx2 s[28:29], s[0:1], 72
    s_load_dwordx2 s[36:37], s[0:1], 40
    s_load_dwordx2 s[38:39], s[0:1], 56
    s_mov_b32 s14, 819200
    s_mov_b32 s15, s7
    s_mov_b32 s18, 6291456
    s_mov_b32 s19, s7
    s_mov_b32 s22, s18
    s_mov_b32 s23, s7
    s_mov_b32 s26, 25165824
    s_mov_b32 s27, s7
    s_mov_b32 s30, s6
    s_mov_b32 s31, s7
    s_mov_b32 s34, 256
    s_mov_b32 s35, s7
    s_lshr_b32 s3, s43, 2
    s_lshl_b32 s3, s3, 5
    s_add_u32 s3, s3, s44
    s_min_u32 s3, s3, 59
    s_mul_i32 s101, s3, 52
    s_lshr_b32 s101, s101, 8
    s_mul_i32 s100, s101, 5
    s_sub_u32 s100, s3, s100
    s_waitcnt lgkmcnt(0)
    v_lshrrev_b32 v33, 4, v0
    v_add_u32 v33, s49, v33
    v_mul_u32_u24 v32, 3072, v33
    v_lshl_add_u32 v51, v34, 4, v32
    v_add_u32 v52, 11264, v51
    v_xor_b32 v54, 32, v51
    v_add_u32 v53, 22528, v54
    v_add_u32 v54, 33792, v54
    v_mul_u32_u24 v32, 1280, v33
    v_lshl_add_u32 v47, v34, 4, v32
    v_add_u32 v48, 4096, v47
    v_xor_b32 v50, 32, v47
    v_add_u32 v49, 8192, v50
    v_add_u32 v50, 12288, v50
    s_and_b32 s66, s43, 3
    s_mul_i32 s55, s66, 256
    s_add_u32 s55, s55, 15285248
    v_mul_u32_u24 v33, 4, v0
    s_lshr_b32 s67, s44, 2
    s_add_u32 s67, s67, s44
    s_and_b32 s67, s67, 3
    s_cmp_ge_u32 s43, 4
    s_cselect_b32 s60, 12, 14
    s_cselect_b32 s61, 5, 4
    s_mov_b32 s62, 4682
    s_cmov_b32 s62, 5462
    s_cselect_b32 s63, 1536, 0
    s_mul_i32 s64, s60, s61
    s_sub_u32 s64, s64, 1
    v_min_u32 v32, s64, v0
    v_mul_u32_u24 v35, s62, v32
    v_lshrrev_b32 v35, 16, v35
    v_mul_u32_u24 v36, s60, v35
    v_sub_u32 v32, v32, v36
    s_lshl_b32 s64, s44, 2
    s_add_u32 s64, s64, s48
    s_mul_i32 s64, s64, s61
    v_add_u32 v35, s64, v35
    v_min_u32 v35, 511, v35
    v_mul_u32_u24 v35, 3072, v35
    v_lshl_add_u32 v32, v32, 7, v35
    s_mul_i32 s64, s66, 1572864
    s_add_u32 s64, s64, s63
    s_mul_i32 s67, s44, s61
    s_mul_i32 s67, s67, 5
    s_lshr_b32 s67, s67, 7
    s_cmp_ge_u32 s43, 4
    s_cselect_b32 s67, 63, s67
    s_and_b32 s68, s44, 1
    s_lshr_b32 s69, s42, 2
    v_and_b32 v23, 31, v0
    v_lshrrev_b32 v24, 5, v0
    v_and_b32 v30, 15, v0
    v_lshrrev_b32 v31, 4, v0
    s_mul_i32 s70, s68, 3
    v_add_u32 v17, s70, v31
    v_cmp_gt_u32 vcc, 2, v31
    v_add_u32 v25, s70, v24
    s_lshl_b32 s71, s42, 8
    v_cndmask_b32 v17, 2, v17, vcc
    v_lshlrev_b32 v17, 15, v17
    v_lshl_add_u32 v17, v30, 4, v17
    v_add_u32 v17, s71, v17
    v_cmp_lt_u32 vcc, 20, v0
    s_mul_i32 s71, s42, 640
    v_subrev_u32 v18, 1, v0
    v_cndmask_b32 v18, v0, v18, vcc
    v_lshlrev_b32 v18, 4, v18
    v_add_u32 v18, s71, v18
    v_and_b32 v29, 1, v31
    v_mul_u32_u24 v15, 768, v29
    v_lshl_add_u32 v15, v30, 4, v15
    s_mul_i32 s71, s69, 3072
    s_add_u32 s71, s71, 117504
    v_add_u32 v15, s71, v15
    v_lshl_add_u32 v14, v24, 8, v15
    s_lshl_b32 s70, s68, 3
    s_add_u32 s71, s70, 512
    v_add_u32 v15, s71, v15
    v_min_u32 v16, 20, v23
    v_mul_u32_u24 v28, 336, v24
    v_mov_b32 v19, 0xdddd
    v_lshl_add_u32 v16, v16, 4, v28
    s_mul_i32 s71, s69, 2688
    s_add_u32 s71, s71, 123648
    v_add_u32 v16, s71, v16
    s_lshl_b32 s71, s42, 2
    s_add_u32 s71, s71, 163584
    v_mov_b32 v20, s71
    v_and_b32 v21, 7, v0
    v_lshlrev_b32 v21, 2, v21
    v_add_u32 v21, 163584, v21
    v_mov_b32 v22, 1
    v_lshlrev_b32 v25, 15, v25
    v_lshl_add_u32 v25, v23, 4, v25
    v_lshlrev_b32 v26, 4, v23
    s_add_u32 s70, s70, 0x10000
    v_add_u32 v26, s70, v26
    v_lshlrev_b32 v27, 2, v23
    s_mov_b32 exec_lo, 0xfee00000
    s_mov_b32 exec_hi, 0xfee00000
    v_mov_b32 v16, 0x30000
    s_mov_b32 exec_lo, 0
    s_mov_b32 exec_hi, -1
    v_mov_b32 v15, 0x30000
    s_mov_b64 exec, -1
    s_cmp_eq_u32 s42, 0
    s_cbranch_scc1 gated_mix__mha_block__mixer_token_mlp__prompt_kernel_vs8
    v_mul_u32_u24 v28, 11520, v31
    v_mul_u32_u24 v29, 336, v30
    v_add_u32 v28, v28, v29
    v_add_u32 v28, 123968, v28
    s_branch gated_mix__mha_block__mixer_token_mlp__prompt_kernel_vs9
gated_mix__mha_block__mixer_token_mlp__prompt_kernel_vs8:
    s_lshl_b32 s70, s43, 2
    s_and_b32 s71, s44, 3
    s_add_u32 s70, s70, s71
    s_lshr_b32 s71, s70, 1
    s_mul_i32 s71, s71, 5
    s_lshl_b32 s68, s68, 1
    s_add_u32 s71, s71, s68
    s_and_b32 s71, s71, 7
    s_cmp_ge_u32 s71, 6
    s_cselect_b32 s71, 64, 32
    v_mov_b32 v29, s71
    s_lshr_b32 s71, s71, 3
    v_writelane_b32 v29, s71, 2
    s_lshl_b32 s70, s70, 6
    v_lshl_add_u32 v28, v0, 11, s70
    s_lshr_b32 s71, s44, 2
    s_add_u32 s71, s71, 2
    s_lshl_b32 s71, s71, 11
    s_add_u32 s71, s71, s70
    v_writelane_b32 v28, s71, 2
gated_mix__mha_block__mixer_token_mlp__prompt_kernel_vs9:
    s_lshl_b32 s54, s53, 7
    s_add_u32 m0, s52, 32768
    s_add_u32 s54, s54, s50
    buffer_load_dwordx4 v39, s[4:7], s54 offen offset:0 lds
    buffer_load_dwordx4 v40, s[4:7], s54 offen offset:1024 lds
    buffer_load_dwordx4 v41, s[4:7], s54 offen offset:2048 lds
    buffer_load_dwordx4 v42, s[4:7], s54 offen offset:3072 lds
    s_mul_i32 s54, s53, 245760
    s_add_u32 m0, s52, 49152
    s_add_u32 s54, s54, s51
    buffer_load_dwordx4 v43, s[8:11], s54 offen offset:0 lds
    buffer_load_dwordx4 v44, s[8:11], s54 offen offset:1024 lds
    buffer_load_dwordx4 v45, s[8:11], s54 offen offset:2048 lds
    buffer_load_dwordx4 v46, s[8:11], s54 offen offset:3072 lds
    s_add_u32 s53, s53, 1
    s_cmp_eq_u32 s53, 10
    s_cselect_b32 s53, 0, s53
    s_waitcnt vmcnt(8)
    s_barrier
    s_lshl_b32 s54, s53, 7
    s_add_u32 m0, s52, 65536
    s_add_u32 s54, s54, s50
    buffer_load_dwordx4 v39, s[4:7], s54 offen offset:0 lds
    buffer_load_dwordx4 v40, s[4:7], s54 offen offset:1024 lds
    buffer_load_dwordx4 v41, s[4:7], s54 offen offset:2048 lds
    buffer_load_dwordx4 v42, s[4:7], s54 offen offset:3072 lds
    s_mul_i32 s54, s53, 245760
    s_add_u32 m0, s52, 81920
    s_add_u32 s54, s54, s51
    buffer_load_dwordx4 v43, s[8:11], s54 offen offset:0 lds
    buffer_load_dwordx4 v44, s[8:11], s54 offen offset:1024 lds
    buffer_load_dwordx4 v45, s[8:11], s54 offen offset:2048 lds
    buffer_load_dwordx4 v46, s[8:11], s54 offen offset:3072 lds
    s_add_u32 s53, s53, 1
    s_cmp_eq_u32 s53, 10
    s_cselect_b32 s53, 0, s53
    s_waitcnt vmcnt(8)
    s_barrier
    s_lshl_b32 s54, s53, 7
    s_add_u32 m0, s52, 98304
    s_add_u32 s54, s54, s50
    buffer_load_dwordx4 v39, s[4:7], s54 offen offset:0 lds
    buffer_load_dwordx4 v40, s[4:7], s54 offen offset:1024 lds
    buffer_load_dwordx4 v41, s[4:7], s54 offen offset:2048 lds
    buffer_load_dwordx4 v42, s[4:7], s54 offen offset:3072 lds
    s_mul_i32 s54, s53, 245760
    s_add_u32 m0, s52, 114688
    s_add_u32 s54, s54, s51
    buffer_load_dwordx4 v43, s[8:11], s54 offen offset:0 lds
    buffer_load_dwordx4 v44, s[8:11], s54 offen offset:1024 lds
    buffer_load_dwordx4 v45, s[8:11], s54 offen offset:2048 lds
    buffer_load_dwordx4 v46, s[8:11], s54 offen offset:3072 lds
    s_add_u32 s53, s53, 1
    s_cmp_eq_u32 s53, 10
    s_cselect_b32 s53, 0, s53
    s_cmp_eq_u32 s67, 0
    s_cselect_b32 s54, s64, 0x1000000
    buffer_load_dword v165, v32, s[16:19], s54 offen
    s_waitcnt vmcnt(9)
    s_barrier
    s_lshl_b32 s54, s53, 7
    s_add_u32 m0, s52, 0
    s_add_u32 s54, s54, s50
    buffer_load_dwordx4 v39, s[4:7], s54 offen offset:0 lds
    buffer_load_dwordx4 v40, s[4:7], s54 offen offset:1024 lds
    buffer_load_dwordx4 v41, s[4:7], s54 offen offset:2048 lds
    buffer_load_dwordx4 v42, s[4:7], s54 offen offset:3072 lds
    s_mul_i32 s54, s53, 245760
    s_add_u32 m0, s52, 16384
    s_add_u32 s54, s54, s51
    buffer_load_dwordx4 v43, s[8:11], s54 offen offset:0 lds
    buffer_load_dwordx4 v44, s[8:11], s54 offen offset:1024 lds
    buffer_load_dwordx4 v45, s[8:11], s54 offen offset:2048 lds
    buffer_load_dwordx4 v46, s[8:11], s54 offen offset:3072 lds
    s_add_u32 s53, s53, 1
    s_cmp_eq_u32 s53, 10
    s_cselect_b32 s53, 0, s53
    s_cmp_eq_u32 s67, 1
    s_cselect_b32 s54, s64, 0x1000000
    buffer_load_dword v165, v32, s[16:19], s54 offen
    s_waitcnt vmcnt(10)
    s_barrier
    s_lshl_b32 s54, s53, 7
    s_add_u32 m0, s52, 32768
    s_add_u32 s54, s54, s50
    buffer_load_dwordx4 v39, s[4:7], s54 offen offset:0 lds
    buffer_load_dwordx4 v40, s[4:7], s54 offen offset:1024 lds
    buffer_load_dwordx4 v41, s[4:7], s54 offen offset:2048 lds
    buffer_load_dwordx4 v42, s[4:7], s54 offen offset:3072 lds
    s_mul_i32 s54, s53, 245760
    s_add_u32 m0, s52, 49152
    s_add_u32 s54, s54, s51
    buffer_load_dwordx4 v43, s[8:11], s54 offen offset:0 lds
    buffer_load_dwordx4 v44, s[8:11], s54 offen offset:1024 lds
    buffer_load_dwordx4 v45, s[8:11], s54 offen offset:2048 lds
    buffer_load_dwordx4 v46, s[8:11], s54 offen offset:3072 lds
    s_add_u32 s53, s53, 1
    s_cmp_eq_u32 s53, 10
    s_cselect_b32 s53, 0, s53
    s_cmp_eq_u32 s67, 2
    s_cselect_b32 s54, s64, 0x1000000
    buffer_load_dword v165, v32, s[16:19], s54 offen
    s_waitcnt vmcnt(10)
    s_barrier
    s_lshl_b32 s54, s53, 7
    s_add_u32 m0, s52, 65536
    s_add_u32 s54, s54, s50
    buffer_load_dwordx4 v39, s[4:7], s54 offen offset:0 lds
    buffer_load_dwordx4 v40, s[4:7], s54 offen offset:1024 lds
    buffer_load_dwordx4 v41, s[4:7], s54 offen offset:2048 lds
    buffer_load_dwordx4 v42, s[4:7], s54 offen offset:3072 lds
    s_mul_i32 s54, s53, 245760
    s_add_u32 m0, s52, 81920
    s_add_u32 s54, s54, s51
    buffer_load_dwordx4 v43, s[8:11], s54 offen offset:0 lds
    buffer_load_dwordx4 v44, s[8:11], s54 offen offset:1024 lds
    buffer_load_dwordx4 v45, s[8:11], s54 offen offset:2048 lds
    buffer_load_dwordx4 v46, s[8:11], s54 offen offset:3072 lds
    s_add_u32 s53, s53, 1
    s_cmp_eq_u32 s53, 10
    s_cselect_b32 s53, 0, s53
    s_cmp_eq_u32 s67, 3
    s_cselect_b32 s54, s64, 0x1000000
    buffer_load_dword v165, v32, s[16:19], s54 offen
    s_waitcnt vmcnt(10)
    s_barrier
    s_lshl_b32 s54, s53, 7
    s_add_u32 m0, s52, 98304
    s_add_u32 s54, s54, s50
    buffer_load_dwordx4 v39, s[4:7], s54 offen offset:0 lds
    buffer_load_dwordx4 v40, s[4:7], s54 offen offset:1024 lds
    buffer_load_dwordx4 v41, s[4:7], s54 offen offset:2048 lds
    buffer_load_dwordx4 v42, s[4:7], s54 offen offset:3072 lds
    s_mul_i32 s54, s53, 245760
    s_add_u32 m0, s52, 114688
    s_add_u32 s54, s54, s51
    buffer_load_dwordx4 v43, s[8:11], s54 offen offset:0 lds
    buffer_load_dwordx4 v44, s[8:11], s54 offen offset:1024 lds
    buffer_load_dwordx4 v45, s[8:11], s54 offen offset:2048 lds
    buffer_load_dwordx4 v46, s[8:11], s54 offen offset:3072 lds
    s_add_u32 s53, s53, 1
    s_cmp_eq_u32 s53, 10
    s_cselect_b32 s53, 0, s53
    s_cmp_eq_u32 s67, 4
    s_cselect_b32 s54, s64, 0x1000000
    buffer_load_dword v165, v32, s[16:19], s54 offen
    s_waitcnt vmcnt(10)
    s_barrier
    s_lshl_b32 s54, s53, 7
    s_add_u32 m0, s52, 0
    s_add_u32 s54, s54, s50
    buffer_load_dwordx4 v39, s[4:7], s54 offen offset:0 lds
    buffer_load_dwordx4 v40, s[4:7], s54 offen offset:1024 lds
    buffer_load_dwordx4 v41, s[4:7], s54 offen offset:2048 lds
    buffer_load_dwordx4 v42, s[4:7], s54 offen offset:3072 lds
    s_mul_i32 s54, s53, 245760
    s_add_u32 m0, s52, 16384
    s_add_u32 s54, s54, s51
    buffer_load_dwordx4 v43, s[8:11], s54 offen offset:0 lds
    buffer_load_dwordx4 v44, s[8:11], s54 offen offset:1024 lds
    buffer_load_dwordx4 v45, s[8:11], s54 offen offset:2048 lds
    buffer_load_dwordx4 v46, s[8:11], s54 offen offset:3072 lds
    s_add_u32 s53, s53, 1
    s_cmp_eq_u32 s53, 10
    s_cselect_b32 s53, 0, s53
    s_waitcnt vmcnt(9)
    s_barrier
    buffer_load_dword v34, v33, s[24:27], s55 offen offset:0 sc1
    s_lshl_b32 s54, s53, 7
    s_add_u32 m0, s52, 32768
    s_add_u32 s54, s54, s50
    buffer_load_dwordx4 v39, s[4:7], s54 offen offset:0 lds
    buffer_load_dwordx4 v40, s[4:7], s54 offen offset:1024 lds
    buffer_load_dwordx4 v41, s[4:7], s54 offen offset:2048 lds
    buffer_load_dwordx4 v42, s[4:7], s54 offen offset:3072 lds
    s_mul_i32 s54, s53, 245760
    s_add_u32 m0, s52, 49152
    s_add_u32 s54, s54, s51
    buffer_load_dwordx4 v43, s[8:11], s54 offen offset:0 lds
    buffer_load_dwordx4 v44, s[8:11], s54 offen offset:1024 lds
    buffer_load_dwordx4 v45, s[8:11], s54 offen offset:2048 lds
    buffer_load_dwordx4 v46, s[8:11], s54 offen offset:3072 lds
    s_add_u32 s53, s53, 1
    s_cmp_eq_u32 s53, 10
    s_cselect_b32 s53, 0, s53
    s_waitcnt vmcnt(9)
    s_barrier
    s_mov_b32 s45, 200000
    s_waitcnt vmcnt(8)
    s_branch gated_mix__mha_block__mixer_token_mlp__prompt_kernel_pollc12
gated_mix__mha_block__mixer_token_mlp__prompt_kernel_poll10:
    buffer_load_dword v34, v33, s[24:27], s55 offen offset:0 sc1
    s_waitcnt vmcnt(0)
gated_mix__mha_block__mixer_token_mlp__prompt_kernel_pollc12:
    v_cmp_eq_u32 vcc, 0, v34
    s_cbranch_vccz gated_mix__mha_block__mixer_token_mlp__prompt_kernel_polld11
    s_sleep 8
    s_sub_u32 s45, s45, 1
    s_cbranch_scc0 gated_mix__mha_block__mixer_token_mlp__prompt_kernel_poll10
gated_mix__mha_block__mixer_token_mlp__prompt_kernel_polld11:
    s_mul_i32 s50, s66, 655360
    s_lshl_b32 s54, s100, 8
    s_add_u32 s50, s50, s54
    s_add_u32 s50, s50, 7864320
    s_mul_i32 s51, s66, 1572864
    s_lshl_b32 s54, s101, 8
    s_add_u32 s51, s51, s54
    s_mov_b32 s53, 0
    s_mul_i32 s54, s53, 81920
    s_add_u32 m0, s52, 65536
    s_add_u32 s54, s54, s50
    buffer_load_dwordx4 v47, s[24:27], s54 offen offset:0 sc1 lds
    buffer_load_dwordx4 v48, s[24:27], s54 offen offset:1024 sc1 lds
    buffer_load_dwordx4 v49, s[24:27], s54 offen offset:2048 sc1 lds
    buffer_load_dwordx4 v50, s[24:27], s54 offen offset:3072 sc1 lds
    s_mul_i32 s54, s53, 196608
    s_add_u32 m0, s52, 81920
    s_add_u32 s54, s54, s51
    buffer_load_dwordx4 v51, s[16:19], s54 offen offset:0 lds
    buffer_load_dwordx4 v52, s[16:19], s54 offen offset:1024 lds
    buffer_load_dwordx4 v53, s[16:19], s54 offen offset:2048 lds
    buffer_load_dwordx4 v54, s[16:19], s54 offen offset:3072 lds
    s_add_u32 s53, s53, 1
    s_and_b32 s53, s53, 7
    s_waitcnt vmcnt(8)
    s_barrier
    s_mul_i32 s54, s53, 81920
    s_add_u32 m0, s52, 98304
    s_add_u32 s54, s54, s50
    buffer_load_dwordx4 v47, s[24:27], s54 offen offset:0 sc1 lds
    buffer_load_dwordx4 v48, s[24:27], s54 offen offset:1024 sc1 lds
    buffer_load_dwordx4 v49, s[24:27], s54 offen offset:2048 sc1 lds
    buffer_load_dwordx4 v50, s[24:27], s54 offen offset:3072 sc1 lds
    s_mul_i32 s54, s53, 196608
    s_add_u32 m0, s52, 114688
    s_add_u32 s54, s54, s51
    buffer_load_dwordx4 v51, s[16:19], s54 offen offset:0 lds
    buffer_load_dwordx4 v52, s[16:19], s54 offen offset:1024 lds
    buffer_load_dwordx4 v53, s[16:19], s54 offen offset:2048 lds
    buffer_load_dwordx4 v54, s[16:19], s54 offen offset:3072 lds
    s_add_u32 s53, s53, 1
    s_and_b32 s53, s53, 7
    s_waitcnt vmcnt(8)
    s_barrier
    s_mul_i32 s54, s53, 81920
    s_add_u32 m0, s52, 0
    s_add_u32 s54, s54, s50
    buffer_load_dwordx4 v47, s[24:27], s54 offen offset:0 sc1 lds
    buffer_load_dwordx4 v48, s[24:27], s54 offen offset:1024 sc1 lds
    buffer_load_dwordx4 v49, s[24:27], s54 offen offset:2048 sc1 lds
    buffer_load_dwordx4 v50, s[24:27], s54 offen offset:3072 sc1 lds
    s_mul_i32 s54, s53, 196608
    s_add_u32 m0, s52, 16384
    s_add_u32 s54, s54, s51
    buffer_load_dwordx4 v51, s[16:19], s54 offen offset:0 lds
    buffer_load_dwordx4 v52, s[16:19], s54 offen offset:1024 lds
    buffer_load_dwordx4 v53, s[16:19], s54 offen offset:2048 lds
    buffer_load_dwordx4 v54, s[16:19], s54 offen offset:3072 lds
    s_add_u32 s53, s53, 1
    s_and_b32 s53, s53, 7
    s_waitcnt vmcnt(8)
    s_barrier
    s_mul_i32 s54, s53, 81920
    s_add_u32 m0, s52, 32768
    s_add_u32 s54, s54, s50
    buffer_load_dwordx4 v47, s[24:27], s54 offen offset:0 sc1 lds
    buffer_load_dwordx4 v48, s[24:27], s54 offen offset:1024 sc1 lds
    buffer_load_dwordx4 v49, s[24:27], s54 offen offset:2048 sc1 lds
    buffer_load_dwordx4 v50, s[24:27], s54 offen offset:3072 sc1 lds
    s_mul_i32 s54, s53, 196608
    s_add_u32 m0, s52, 49152
    s_add_u32 s54, s54, s51
    buffer_load_dwordx4 v51, s[16:19], s54 offen offset:0 lds
    buffer_load_dwordx4 v52, s[16:19], s54 offen offset:1024 lds
    buffer_load_dwordx4 v53, s[16:19], s54 offen offset:2048 lds
    buffer_load_dwordx4 v54, s[16:19], s54 offen offset:3072 lds
    s_add_u32 s53, s53, 1
    s_and_b32 s53, s53, 7
    s_waitcnt vmcnt(8)
    s_barrier
    s_mul_i32 s54, s53, 81920
    s_add_u32 m0, s52, 65536
    s_add_u32 s54, s54, s50
    buffer_load_dwordx4 v47, s[24:27], s54 offen offset:0 sc1 lds
    buffer_load_dwordx4 v48, s[24:27], s54 offen offset:1024 sc1 lds
    buffer_load_dwordx4 v49, s[24:27], s54 offen offset:2048 sc1 lds
    buffer_load_dwordx4 v50, s[24:27], s54 offen offset:3072 sc1 lds
    s_mul_i32 s54, s53, 196608
    s_add_u32 m0, s52, 81920
    s_add_u32 s54, s54, s51
    buffer_load_dwordx4 v51, s[16:19], s54 offen offset:0 lds
    buffer_load_dwordx4 v52, s[16:19], s54 offen offset:1024 lds
    buffer_load_dwordx4 v53, s[16:19], s54 offen offset:2048 lds
    buffer_load_dwordx4 v54, s[16:19], s54 offen offset:3072 lds
    s_add_u32 s53, s53, 1
    s_and_b32 s53, s53, 7
    s_waitcnt vmcnt(8)
    s_barrier
    s_mul_i32 s54, s53, 81920
    s_add_u32 m0, s52, 98304
    s_add_u32 s54, s54, s50
    buffer_load_dwordx4 v47, s[24:27], s54 offen offset:0 sc1 lds
    buffer_load_dwordx4 v48, s[24:27], s54 offen offset:1024 sc1 lds
    buffer_load_dwordx4 v49, s[24:27], s54 offen offset:2048 sc1 lds
    buffer_load_dwordx4 v50, s[24:27], s54 offen offset:3072 sc1 lds
    s_mul_i32 s54, s53, 196608
    s_add_u32 m0, s52, 114688
    s_add_u32 s54, s54, s51
    buffer_load_dwordx4 v51, s[16:19], s54 offen offset:0 lds
    buffer_load_dwordx4 v52, s[16:19], s54 offen offset:1024 lds
    buffer_load_dwordx4 v53, s[16:19], s54 offen offset:2048 lds
    buffer_load_dwordx4 v54, s[16:19], s54 offen offset:3072 lds
    s_add_u32 s53, s53, 1
    s_and_b32 s53, s53, 7
    s_waitcnt vmcnt(8)
    s_barrier
    s_mul_i32 s54, s53, 81920
    s_add_u32 m0, s52, 0
    s_add_u32 s54, s54, s50
    buffer_load_dwordx4 v47, s[24:27], s54 offen offset:0 sc1 lds
    buffer_load_dwordx4 v48, s[24:27], s54 offen offset:1024 sc1 lds
    buffer_load_dwordx4 v49, s[24:27], s54 offen offset:2048 sc1 lds
    buffer_load_dwordx4 v50, s[24:27], s54 offen offset:3072 sc1 lds
    s_mul_i32 s54, s53, 196608
    s_add_u32 m0, s52, 16384
    s_add_u32 s54, s54, s51
    buffer_load_dwordx4 v51, s[16:19], s54 offen offset:0 lds
    buffer_load_dwordx4 v52, s[16:19], s54 offen offset:1024 lds
    buffer_load_dwordx4 v53, s[16:19], s54 offen offset:2048 lds
    buffer_load_dwordx4 v54, s[16:19], s54 offen offset:3072 lds
    s_add_u32 s53, s53, 1
    s_and_b32 s53, s53, 7
    s_waitcnt vmcnt(8)
    s_barrier
    s_mul_i32 s54, s53, 81920
    s_add_u32 m0, s52, 32768
    s_add_u32 s54, s54, s50
    buffer_load_dwordx4 v47, s[24:27], s54 offen offset:0 sc1 lds
    buffer_load_dwordx4 v48, s[24:27], s54 offen offset:1024 sc1 lds
    buffer_load_dwordx4 v49, s[24:27], s54 offen offset:2048 sc1 lds
    buffer_load_dwordx4 v50, s[24:27], s54 offen offset:3072 sc1 lds
    s_mul_i32 s54, s53, 196608
    s_add_u32 m0, s52, 49152
    s_add_u32 s54, s54, s51
    buffer_load_dwordx4 v51, s[16:19], s54 offen offset:0 lds
    buffer_load_dwordx4 v52, s[16:19], s54 offen offset:1024 lds
    buffer_load_dwordx4 v53, s[16:19], s54 offen offset:2048 lds
    buffer_load_dwordx4 v54, s[16:19], s54 offen offset:3072 lds
    s_add_u32 s53, s53, 1
    s_and_b32 s53, s53, 7
    s_waitcnt vmcnt(8)
    s_barrier
    s_branch gated_mix__mha_block__mixer_token_mlp__prompt_kernel_att
gated_mix__mha_block__mixer_token_mlp__prompt_kernel_idle:
    s_getpc_b64 s[50:51]
gated_mix__mha_block__mixer_token_mlp__prompt_kernel_pc13:
    s_sub_u32 s50, s50, gated_mix__mha_block__mixer_token_mlp__prompt_kernel_pc13-gated_mix__mha_block__mixer_token_mlp__prompt_kernel
    s_subb_u32 s51, s51, 0
    s_lshl_b32 s52, s44, 3
    v_cmp_gt_u32 vcc, 64, v0
    v_add_u32 v1, s52, v0
    s_movk_i32 s54, 72
    v_cmp_gt_u32 s[52:53], s54, v0
    v_cndmask_b32 v1, v1, v0, vcc
    v_lshlrev_b32 v1, 7, v1
    v_min_u32 v1, code_end-gated_mix__mha_block__mixer_token_mlp__prompt_kernel-4, v1
    s_mov_b64 exec, s[52:53]
    s_cbranch_execz gated_mix__mha_block__mixer_token_mlp__prompt_kernel_pc14
    global_load_dword v165, v1, s[50:51]
gated_mix__mha_block__mixer_token_mlp__prompt_kernel_pc14:
    s_mov_b64 exec, -1
    v_and_b32 v0, 63, v0
    s_load_dwordx2 s[24:25], s[0:1], 88
    s_load_dwordx2 s[32:33], s[0:1], 80
    s_load_dwordx2 s[16:17], s[0:1], 32
    s_load_dwordx2 s[20:21], s[0:1], 48
    s_load_dwordx2 s[12:13], s[0:1], 16
    s_load_dwordx2 s[28:29], s[0:1], 72
    s_load_dwordx2 s[36:37], s[0:1], 40
    s_load_dwordx2 s[38:39], s[0:1], 56
    s_mov_b32 s14, 819200
    s_mov_b32 s15, s7
    s_mov_b32 s18, 6291456
    s_mov_b32 s19, s7
    s_mov_b32 s22, s18
    s_mov_b32 s23, s7
    s_mov_b32 s26, 25165824
    s_mov_b32 s27, s7
    s_mov_b32 s30, s6
    s_mov_b32 s31, s7
    s_mov_b32 s34, 256
    s_mov_b32 s35, s7
    s_lshr_b32 s3, s43, 2
    s_lshl_b32 s3, s3, 5
    s_add_u32 s3, s3, s44
    s_min_u32 s3, s3, 59
    s_mul_i32 s101, s3, 52
    s_lshr_b32 s101, s101, 8
    s_mul_i32 s100, s101, 5
    s_sub_u32 s100, s3, s100
    s_waitcnt lgkmcnt(0)
    s_waitcnt lgkmcnt(0)
    s_cmp_lg_u32 s42, 0
    s_cbranch_scc1 gated_mix__mha_block__mixer_token_mlp__prompt_kernel_idle15
    v_lshlrev_b32 v1, 4, v0
    v_mov_b32 v4, 0
    v_mov_b32 v5, 0
    v_mov_b32 v6, 0
    v_mov_b32 v7, 0
    s_mul_i32 s52, s46, 5120
    s_add_u32 s52, s52, 15269888
    buffer_store_dwordx4 v[4:7], v1, s[24:27], s52 offen offset:0 sc1
    buffer_store_dwordx4 v[4:7], v1, s[24:27], s52 offen offset:1024 sc1
    buffer_store_dwordx4 v[4:7], v1, s[24:27], s52 offen offset:2048 sc1
    buffer_store_dwordx4 v[4:7], v1, s[24:27], s52 offen offset:3072 sc1
    s_add_u32 s52, s52, 4096
    buffer_store_dwordx4 v[4:7], v1, s[24:27], s52 offen offset:0 sc1
    s_lshl_b32 s52, s46, 2
    s_mov_b64 exec, 1
    s_waitcnt vmcnt(0)
    v_mov_b32 v5, 1
    buffer_store_dword v5, v4, s[32:35], s52 offen sc1
    s_mov_b64 exec, -1
gated_mix__mha_block__mixer_token_mlp__prompt_kernel_idle15:
    s_and_b32 s68, s44, 1
    s_lshr_b32 s69, s42, 2
    v_and_b32 v23, 31, v0
    v_lshrrev_b32 v24, 5, v0
    v_and_b32 v30, 15, v0
    v_lshrrev_b32 v31, 4, v0
    s_mul_i32 s70, s68, 3
    v_add_u32 v17, s70, v31
    v_cmp_gt_u32 vcc, 2, v31
    v_add_u32 v25, s70, v24
    s_lshl_b32 s71, s42, 8
    v_cndmask_b32 v17, 2, v17, vcc
    v_lshlrev_b32 v17, 15, v17
    v_lshl_add_u32 v17, v30, 4, v17
    v_add_u32 v17, s71, v17
    v_cmp_lt_u32 vcc, 20, v0
    s_mul_i32 s71, s42, 640
    v_subrev_u32 v18, 1, v0
    v_cndmask_b32 v18, v0, v18, vcc
    v_lshlrev_b32 v18, 4, v18
    v_add_u32 v18, s71, v18
    v_and_b32 v29, 1, v31
    v_mul_u32_u24 v15, 768, v29
    v_lshl_add_u32 v15, v30, 4, v15
    s_mul_i32 s71, s69, 3072
    s_add_u32 s71, s71, 117504
    v_add_u32 v15, s71, v15
    v_lshl_add_u32 v14, v24, 8, v15
    s_lshl_b32 s70, s68, 3
    s_add_u32 s71, s70, 512
    v_add_u32 v15, s71, v15
    v_min_u32 v16, 20, v23
    v_mul_u32_u24 v28, 336, v24
    v_mov_b32 v19, 0xdddd
    v_lshl_add_u32 v16, v16, 4, v28
    s_mul_i32 s71, s69, 2688
    s_add_u32 s71, s71, 123648
    v_add_u32 v16, s71, v16
    s_lshl_b32 s71, s42, 2
    s_add_u32 s71, s71, 163584
    v_mov_b32 v20, s71
    v_and_b32 v21, 7, v0
    v_lshlrev_b32 v21, 2, v21
    v_add_u32 v21, 163584, v21
    v_mov_b32 v22, 1
    v_lshlrev_b32 v25, 15, v25
    v_lshl_add_u32 v25, v23, 4, v25
    v_lshlrev_b32 v26, 4, v23
    s_add_u32 s70, s70, 0x10000
    v_add_u32 v26, s70, v26
    v_lshlrev_b32 v27, 2, v23
    s_mov_b32 exec_lo, 0xfee00000
    s_mov_b32 exec_hi, 0xfee00000
    v_mov_b32 v16, 0x30000
    s_mov_b32 exec_lo, 0
    s_mov_b32 exec_hi, -1
    v_mov_b32 v15, 0x30000
    s_mov_b64 exec, -1
    s_cmp_eq_u32 s42, 0
    s_cbranch_scc1 gated_mix__mha_block__mixer_token_mlp__prompt_kernel_vs16
    v_mul_u32_u24 v28, 11520, v31
    v_mul_u32_u24 v29, 336, v30
    v_add_u32 v28, v28, v29
    v_add_u32 v28, 123968, v28
    s_branch gated_mix__mha_block__mixer_token_mlp__prompt_kernel_vs17
gated_mix__mha_block__mixer_token_mlp__prompt_kernel_vs16:
    s_lshl_b32 s70, s43, 2
    s_and_b32 s71, s44, 3
    s_add_u32 s70, s70, s71
    s_lshr_b32 s71, s70, 1
    s_mul_i32 s71, s71, 5
    s_lshl_b32 s68, s68, 1
    s_add_u32 s71, s71, s68
    s_and_b32 s71, s71, 7
    s_cmp_ge_u32 s71, 6
    s_cselect_b32 s71, 64, 32
    v_mov_b32 v29, s71
    s_lshr_b32 s71, s71, 3
    v_writelane_b32 v29, s71, 2
    s_lshl_b32 s70, s70, 6
    v_lshl_add_u32 v28, v0, 11, s70
    s_lshr_b32 s71, s44, 2
    s_add_u32 s71, s71, 2
    s_lshl_b32 s71, s71, 11
    s_add_u32 s71, s71, s70
    v_writelane_b32 v28, s71, 2
gated_mix__mha_block__mixer_token_mlp__prompt_kernel_vs17:
    s_cmp_ge_u32 s42, 4
    s_cbranch_scc1 gated_mix__mha_block__mixer_token_mlp__prompt_kernel_idle18
    s_barrier
    s_barrier
    s_barrier
    s_barrier
    s_barrier
    s_barrier
    s_barrier
    s_barrier
    s_barrier
    s_barrier
    s_barrier
    s_barrier
    s_barrier
    s_barrier
    s_barrier
    s_branch gated_mix__mha_block__mixer_token_mlp__prompt_kernel_att
gated_mix__mha_block__mixer_token_mlp__prompt_kernel_idle18:
    v_min_u32 v32, 59, v0
    v_mul_u32_u24 v33, 5462, v32
    v_lshrrev_b32 v33, 16, v33
    v_mul_u32_u24 v34, 1536, v33
    v_lshl_add_u32 v32, v32, 7, v34
    s_and_b32 s52, s44, 3
    s_lshl_b32 s52, s52, 2
    s_add_u32 s52, s52, s42
    s_sub_u32 s52, s52, 4
    s_mul_i32 s52, s52, 5
    s_and_b32 s53, s43, 3
    s_mul_i32 s53, s53, 1572864
    s_add_u32 s53, s53, 1536
    s_barrier
    s_min_u32 s54, s52, 507
    s_mul_i32 s54, s54, 3072
    s_add_u32 s54, s54, s53
    buffer_load_dword v166, v32, s[16:19], s54 offen
    s_add_u32 s52, s52, 80
    s_barrier
    s_barrier
    s_barrier
    s_waitcnt vmcnt(0)
    s_min_u32 s54, s52, 507
    s_mul_i32 s54, s54, 3072
    s_add_u32 s54, s54, s53
    buffer_load_dword v166, v32, s[16:19], s54 offen
    s_add_u32 s52, s52, 80
    s_waitcnt vmcnt(0)
    s_min_u32 s54, s52, 507
    s_mul_i32 s54, s54, 3072
    s_add_u32 s54, s54, s53
    buffer_load_dword v166, v32, s[16:19], s54 offen
    s_add_u32 s52, s52, 80
    s_waitcnt vmcnt(0)
    s_min_u32 s54, s52, 507
    s_mul_i32 s54, s54, 3072
    s_add_u32 s54, s54, s53
    buffer_load_dword v166, v32, s[16:19], s54 offen
    s_add_u32 s52, s52, 80
    s_waitcnt vmcnt(0)
    s_min_u32 s54, s52, 507
    s_mul_i32 s54, s54, 3072
    s_add_u32 s54, s54, s53
    buffer_load_dword v166, v32, s[16:19], s54 offen
    s_add_u32 s52, s52, 80
    s_waitcnt vmcnt(0)
    s_min_u32 s54, s52, 507
    s_mul_i32 s54, s54, 3072
    s_add_u32 s54, s54, s53
    buffer_load_dword v166, v32, s[16:19], s54 offen
    s_add_u32 s52, s52, 80
    s_waitcnt vmcnt(0)
    s_min_u32 s54, s52, 507
    s_mul_i32 s54, s54, 3072
    s_add_u32 s54, s54, s53
    buffer_load_dword v166, v32, s[16:19], s54 offen
    s_add_u32 s52, s52, 80
    s_barrier
    s_barrier
    s_barrier
    s_barrier
    s_barrier
    s_barrier
    s_barrier
    s_barrier
    s_barrier
    s_barrier
    s_barrier
    s_barrier
    s_barrier
    s_branch gated_mix__mha_block__mixer_token_mlp__prompt_kernel_att
gated_mix__mha_block__mixer_token_mlp__prompt_kernel_qkv_comp:
    s_getpc_b64 s[50:51]
gated_mix__mha_block__mixer_token_mlp__prompt_kernel_pc19:
    s_sub_u32 s50, s50, gated_mix__mha_block__mixer_token_mlp__prompt_kernel_pc19-gated_mix__mha_block__mixer_token_mlp__prompt_kernel
    s_subb_u32 s51, s51, 0
    s_lshl_b32 s52, s44, 3
    v_cmp_gt_u32 vcc, 64, v0
    v_add_u32 v1, s52, v0
    s_movk_i32 s54, 72
    v_cmp_gt_u32 s[52:53], s54, v0
    v_cndmask_b32 v1, v1, v0, vcc
    v_lshlrev_b32 v1, 7, v1
    v_min_u32 v1, code_end-gated_mix__mha_block__mixer_token_mlp__prompt_kernel-4, v1
    s_mov_b64 exec, s[52:53]
    s_cbranch_execz gated_mix__mha_block__mixer_token_mlp__prompt_kernel_pc20
    global_load_dword v165, v1, s[50:51]
gated_mix__mha_block__mixer_token_mlp__prompt_kernel_pc20:
    s_mov_b64 exec, -1
    v_and_b32 v0, 63, v0
    s_load_dwordx2 s[24:25], s[0:1], 88
    s_load_dwordx2 s[32:33], s[0:1], 80
    s_load_dwordx2 s[16:17], s[0:1], 32
    s_load_dwordx2 s[20:21], s[0:1], 48
    s_load_dwordx2 s[12:13], s[0:1], 16
    s_load_dwordx2 s[28:29], s[0:1], 72
    s_load_dwordx2 s[36:37], s[0:1], 40
    s_load_dwordx2 s[38:39], s[0:1], 56
    s_mov_b32 s14, 819200
    s_mov_b32 s15, s7
    s_mov_b32 s18, 6291456
    s_mov_b32 s19, s7
    s_mov_b32 s22, s18
    s_mov_b32 s23, s7
    s_mov_b32 s26, 25165824
    s_mov_b32 s27, s7
    s_mov_b32 s30, s6
    s_mov_b32 s31, s7
    s_mov_b32 s34, 256
    s_mov_b32 s35, s7
    s_lshr_b32 s3, s43, 2
    s_lshl_b32 s3, s3, 5
    s_add_u32 s3, s3, s44
    s_min_u32 s3, s3, 59
    s_mul_i32 s101, s3, 52
    s_lshr_b32 s101, s101, 8
    s_mul_i32 s100, s101, 5
    s_sub_u32 s100, s3, s100
    s_waitcnt lgkmcnt(0)
    s_waitcnt lgkmcnt(0)
    s_and_b32 s48, s42, 1
    s_lshr_b32 s49, s42, 1
    v_and_b32 v8, 31, v0
    v_lshrrev_b32 v9, 5, v0
    s_lshl_b32 s50, s48, 13
    v_and_b32 v10, 15, v0
    v_lshl_add_u32 v10, v10, 7, s50
    v_bfe_u32 v11, v0, 1, 3
    v_lshrrev_b32 v12, 4, v0
    v_xor_b32 v11, v11, v12
    v_lshl_add_u32 v2, v11, 4, v10
    v_xor_b32 v3, 64, v2
    s_lshl_b32 s50, s49, 2
    v_lshrrev_b32 v10, 4, v0
    v_bfe_u32 v11, v0, 2, 2
    v_lshl_add_u32 v4, v10, 3, v11
    v_lshlrev_b32 v4, 8, v4
    v_and_b32 v10, 1, v10
    v_lshl_add_u32 v10, v11, 1, v10
    v_xor_b32 v10, s50, v10
    v_lshl_add_u32 v4, v10, 5, v4
    v_and_b32 v10, 3, v0
    v_lshl_add_u32 v4, v10, 3, v4
    v_add_u32 v4, 16384, v4
    v_xor_b32 v5, 32, v4
    v_xor_b32 v6, 64, v4
    v_xor_b32 v7, 96, v4
    s_mul_i32 s58, s47, 13
    s_lshr_b32 s58, s58, 6
    s_mul_i32 s59, s58, 5
    s_sub_u32 s59, s47, s59
    s_lshl_b32 s59, s59, 1
    s_add_u32 s59, s59, s49
    v_lshrrev_b32 v10, 1, v0
    v_mul_u32_u24 v10, 5, v10
    v_and_b32 v11, 1, v0
    v_lshl_add_u32 v10, v11, 1, v10
    v_add_u32 v11, 2, v10
    v_lshrrev_b32 v10, 3, v10
    v_lshrrev_b32 v11, 3, v11
    v_cmp_eq_u32 s[56:57], s59, v10
    v_cmp_eq_u32 vcc, s59, v11
    v_lshlrev_b32 v13, 6, v0
    v_mov_b32 v12, 1
    s_lshr_b32 s59, s46, 1
    s_add_u32 s59, s59, 3
    s_cmp_eq_u32 s58, 0
    s_cselect_b32 s58, s59, s58
    s_lshl_b32 s58, s58, 11
    s_add_u32 s58, s58, 15316992
    s_or_b32 s56, s56, vcc_lo
    s_mov_b32 s57, 0
    v_mov_b32 v64, 0
    v_mov_b32 v65, 0
    v_mov_b32 v66, 0
    v_mov_b32 v67, 0
    v_mov_b32 v68, 0
    v_mov_b32 v69, 0
    v_mov_b32 v70, 0
    v_mov_b32 v71, 0
    v_mov_b32 v72, 0
    v_mov_b32 v73, 0
    v_mov_b32 v74, 0
    v_mov_b32 v75, 0
    v_mov_b32 v76, 0
    v_mov_b32 v77, 0
    v_mov_b32 v78, 0
    v_mov_b32 v79, 0
    v_mov_b32 v80, 0
    v_mov_b32 v81, 0
    v_mov_b32 v82, 0
    v_mov_b32 v83, 0
    v_mov_b32 v84, 0
    v_mov_b32 v85, 0
    v_mov_b32 v86, 0
    v_mov_b32 v87, 0
    v_mov_b32 v88, 0
    v_mov_b32 v89, 0
    v_mov_b32 v90, 0
    v_mov_b32 v91, 0
    v_mov_b32 v92, 0
    v_mov_b32 v93, 0
    v_mov_b32 v94, 0
    v_mov_b32 v95, 0
    v_mov_b32 v96, 0
    v_mov_b32 v97, 0
    v_mov_b32 v98, 0
    v_mov_b32 v99, 0
    v_mov_b32 v100, 0
    v_mov_b32 v101, 0
    v_mov_b32 v102, 0
    v_mov_b32 v103, 0
    v_mov_b32 v104, 0
    v_mov_b32 v105, 0
    v_mov_b32 v106, 0
    v_mov_b32 v107, 0
    v_mov_b32 v108, 0
    v_mov_b32 v109, 0
    v_mov_b32 v110, 0
    v_mov_b32 v111, 0
    v_mov_b32 v112, 0
    v_mov_b32 v113, 0
    v_mov_b32 v114, 0
    v_mov_b32 v115, 0
    v_mov_b32 v116, 0
    v_mov_b32 v117, 0
    v_mov_b32 v118, 0
    v_mov_b32 v119, 0
    v_mov_b32 v120, 0
    v_mov_b32 v121, 0
    v_mov_b32 v122, 0
    v_mov_b32 v123, 0
    v_mov_b32 v124, 0
    v_mov_b32 v125, 0
    v_mov_b32 v126, 0
    v_mov_b32 v127, 0
    s_and_b32 s68, s44, 1
    s_lshr_b32 s69, s42, 2
    v_and_b32 v23, 31, v0
    v_lshrrev_b32 v24, 5, v0
    v_and_b32 v30, 15, v0
    v_lshrrev_b32 v31, 4, v0
    s_mul_i32 s70, s68, 3
    v_add_u32 v17, s70, v31
    v_cmp_gt_u32 vcc, 2, v31
    v_add_u32 v25, s70, v24
    s_lshl_b32 s71, s42, 8
    v_cndmask_b32 v17, 2, v17, vcc
    v_lshlrev_b32 v17, 15, v17
    v_lshl_add_u32 v17, v30, 4, v17
    v_add_u32 v17, s71, v17
    v_cmp_lt_u32 vcc, 20, v0
    s_mul_i32 s71, s42, 640
    v_subrev_u32 v18, 1, v0
    v_cndmask_b32 v18, v0, v18, vcc
    v_lshlrev_b32 v18, 4, v18
    v_add_u32 v18, s71, v18
    v_and_b32 v29, 1, v31
    v_mul_u32_u24 v15, 768, v29
    v_lshl_add_u32 v15, v30, 4, v15
    s_mul_i32 s71, s69, 3072
    s_add_u32 s71, s71, 117504
    v_add_u32 v15, s71, v15
    v_lshl_add_u32 v14, v24, 8, v15
    s_lshl_b32 s70, s68, 3
    s_add_u32 s71, s70, 512
    v_add_u32 v15, s71, v15
    v_min_u32 v16, 20, v23
    v_mul_u32_u24 v28, 336, v24
    v_mov_b32 v19, 0xdddd
    v_lshl_add_u32 v16, v16, 4, v28
    s_mul_i32 s71, s69, 2688
    s_add_u32 s71, s71, 123648
    v_add_u32 v16, s71, v16
    s_lshl_b32 s71, s42, 2
    s_add_u32 s71, s71, 163584
    v_mov_b32 v20, s71
    v_and_b32 v21, 7, v0
    v_lshlrev_b32 v21, 2, v21
    v_add_u32 v21, 163584, v21
    v_mov_b32 v22, 1
    v_lshlrev_b32 v25, 15, v25
    v_lshl_add_u32 v25, v23, 4, v25
    v_lshlrev_b32 v26, 4, v23
    s_add_u32 s70, s70, 0x10000
    v_add_u32 v26, s70, v26
    v_lshlrev_b32 v27, 2, v23
    s_mov_b32 exec_lo, 0xfee00000
    s_mov_b32 exec_hi, 0xfee00000
    v_mov_b32 v16, 0x30000
    s_mov_b32 exec_lo, 0
    s_mov_b32 exec_hi, -1
    v_mov_b32 v15, 0x30000
    s_mov_b64 exec, -1
    s_cmp_eq_u32 s42, 0
    s_cbranch_scc1 gated_mix__mha_block__mixer_token_mlp__prompt_kernel_vs21
    v_mul_u32_u24 v28, 11520, v31
    v_mul_u32_u24 v29, 336, v30
    v_add_u32 v28, v28, v29
    v_add_u32 v28, 123968, v28
    s_branch gated_mix__mha_block__mixer_token_mlp__prompt_kernel_vs22
gated_mix__mha_block__mixer_token_mlp__prompt_kernel_vs21:
    s_lshl_b32 s70, s43, 2
    s_and_b32 s71, s44, 3
    s_add_u32 s70, s70, s71
    s_lshr_b32 s71, s70, 1
    s_mul_i32 s71, s71, 5
    s_lshl_b32 s68, s68, 1
    s_add_u32 s71, s71, s68
    s_and_b32 s71, s71, 7
    s_cmp_ge_u32 s71, 6
    s_cselect_b32 s71, 64, 32
    v_mov_b32 v29, s71
    s_lshr_b32 s71, s71, 3
    v_writelane_b32 v29, s71, 2
    s_lshl_b32 s70, s70, 6
    v_lshl_add_u32 v28, v0, 11, s70
    s_lshr_b32 s71, s44, 2
    s_add_u32 s71, s71, 2
    s_lshl_b32 s71, s71, 11
    s_add_u32 s71, s71, s70
    v_writelane_b32 v28, s71, 2
gated_mix__mha_block__mixer_token_mlp__prompt_kernel_vs22:
    s_setprio 2
    s_barrier
    ds_read_b128 v[32:35], v2 offset:0
    ds_read_b64_tr_b16 v[48:49], v4 offset:0
    ds_read_b64_tr_b16 v[50:51], v4 offset:1024
    ds_read_b128 v[36:39], v2 offset:2048
    ds_read_b128 v[40:43], v2 offset:4096
    ds_read_b128 v[44:47], v2 offset:6144
    ds_read_b64_tr_b16 v[52:53], v5 offset:0
    ds_read_b64_tr_b16 v[54:55], v5 offset:1024
    ds_read_b64_tr_b16 v[56:57], v6 offset:0
    ds_read_b64_tr_b16 v[58:59], v6 offset:1024
    ds_read_b64_tr_b16 v[60:61], v7 offset:0
    ds_read_b64_tr_b16 v[62:63], v7 offset:1024
    s_mov_b32 s51, 5
    s_cmp_ge_u32 s47, 10
    s_cbranch_scc1 gated_mix__mha_block__mixer_token_mlp__prompt_kernel_qkv_v
gated_mix__mha_block__mixer_token_mlp__prompt_kernel_gl23:
    s_waitcnt lgkmcnt(6)
    v_mfma_f32_16x16x32_bf16 v[64:67], v[48:51], v[32:35], v[64:67]
    ds_read_b128 v[128:131], v3 offset:0
    v_mfma_f32_16x16x32_bf16 v[72:75], v[48:51], v[36:39], v[72:75]
    ds_read_b64_tr_b16 v[144:145], v4 offset:8192
    v_mfma_f32_16x16x32_bf16 v[96:99], v[48:51], v[40:43], v[96:99]
    ds_read_b64_tr_b16 v[146:147], v4 offset:9216
    v_mfma_f32_16x16x32_bf16 v[104:107], v[48:51], v[44:47], v[104:107]
    ds_read_b128 v[132:135], v3 offset:2048
    s_waitcnt lgkmcnt(8)
    v_mfma_f32_16x16x32_bf16 v[108:111], v[52:55], v[44:47], v[108:111]
    ds_read_b128 v[136:139], v3 offset:4096
    v_mfma_f32_16x16x32_bf16 v[100:103], v[52:55], v[40:43], v[100:103]
    ds_read_b128 v[140:143], v3 offset:6144
    v_mfma_f32_16x16x32_bf16 v[76:79], v[52:55], v[36:39], v[76:79]
    ds_read_b64_tr_b16 v[148:149], v5 offset:8192
    v_mfma_f32_16x16x32_bf16 v[68:71], v[52:55], v[32:35], v[68:71]
    ds_read_b64_tr_b16 v[150:151], v5 offset:9216
    s_waitcnt lgkmcnt(8)
    v_mfma_f32_16x16x32_bf16 v[80:83], v[56:59], v[32:35], v[80:83]
    ds_read_b64_tr_b16 v[152:153], v6 offset:8192
    v_mfma_f32_16x16x32_bf16 v[88:91], v[56:59], v[36:39], v[88:91]
    ds_read_b64_tr_b16 v[154:155], v6 offset:9216
    v_mfma_f32_16x16x32_bf16 v[112:115], v[56:59], v[40:43], v[112:115]
    ds_read_b64_tr_b16 v[156:157], v7 offset:8192
    v_mfma_f32_16x16x32_bf16 v[120:123], v[56:59], v[44:47], v[120:123]
    ds_read_b64_tr_b16 v[158:159], v7 offset:9216
    v_mfma_f32_16x16x32_bf16 v[124:127], v[60:63], v[44:47], v[124:127]
    v_mfma_f32_16x16x32_bf16 v[116:119], v[60:63], v[40:43], v[116:119]
    v_mfma_f32_16x16x32_bf16 v[92:95], v[60:63], v[36:39], v[92:95]
    v_mfma_f32_16x16x32_bf16 v[84:87], v[60:63], v[32:35], v[84:87]
    s_waitcnt lgkmcnt(6)
    v_mfma_f32_16x16x32_bf16 v[64:67], v[144:147], v[128:131], v[64:67]
    s_barrier
    ds_read_b128 v[32:35], v2 offset:32768
    v_mfma_f32_16x16x32_bf16 v[72:75], v[144:147], v[132:135], v[72:75]
    ds_read_b64_tr_b16 v[48:49], v4 offset:32768
    v_mfma_f32_16x16x32_bf16 v[96:99], v[144:147], v[136:139], v[96:99]
    ds_read_b64_tr_b16 v[50:51], v4 offset:33792
    v_mfma_f32_16x16x32_bf16 v[104:107], v[144:147], v[140:143], v[104:107]
    ds_read_b128 v[36:39], v2 offset:34816
    s_waitcnt lgkmcnt(8)
    v_mfma_f32_16x16x32_bf16 v[108:111], v[148:151], v[140:143], v[108:111]
    ds_read_b128 v[40:43], v2 offset:36864
    v_mfma_f32_16x16x32_bf16 v[100:103], v[148:151], v[136:139], v[100:103]
    ds_read_b128 v[44:47], v2 offset:38912
    v_mfma_f32_16x16x32_bf16 v[76:79], v[148:151], v[132:135], v[76:79]
    ds_read_b64_tr_b16 v[52:53], v5 offset:32768
    v_mfma_f32_16x16x32_bf16 v[68:71], v[148:151], v[128:131], v[68:71]
    ds_read_b64_tr_b16 v[54:55], v5 offset:33792
    s_waitcnt lgkmcnt(8)
    v_mfma_f32_16x16x32_bf16 v[80:83], v[152:155], v[128:131], v[80:83]
    ds_read_b64_tr_b16 v[56:57], v6 offset:32768
    v_mfma_f32_16x16x32_bf16 v[88:91], v[152:155], v[132:135], v[88:91]
    ds_read_b64_tr_b16 v[58:59], v6 offset:33792
    v_mfma_f32_16x16x32_bf16 v[112:115], v[152:155], v[136:139], v[112:115]
    ds_read_b64_tr_b16 v[60:61], v7 offset:32768
    v_mfma_f32_16x16x32_bf16 v[120:123], v[152:155], v[140:143], v[120:123]
    ds_read_b64_tr_b16 v[62:63], v7 offset:33792
    v_mfma_f32_16x16x32_bf16 v[124:127], v[156:159], v[140:143], v[124:127]
    v_mfma_f32_16x16x32_bf16 v[116:119], v[156:159], v[136:139], v[116:119]
    v_mfma_f32_16x16x32_bf16 v[92:95], v[156:159], v[132:135], v[92:95]
    v_mfma_f32_16x16x32_bf16 v[84:87], v[156:159], v[128:131], v[84:87]
    s_waitcnt lgkmcnt(6)
    v_mfma_f32_16x16x32_bf16 v[64:67], v[48:51], v[32:35], v[64:67]
    ds_read_b128 v[128:131], v3 offset:32768
    v_mfma_f32_16x16x32_bf16 v[72:75], v[48:51], v[36:39], v[72:75]
    ds_read_b64_tr_b16 v[144:145], v4 offset:40960
    v_mfma_f32_16x16x32_bf16 v[96:99], v[48:51], v[40:43], v[96:99]
    ds_read_b64_tr_b16 v[146:147], v4 offset:41984
    v_mfma_f32_16x16x32_bf16 v[104:107], v[48:51], v[44:47], v[104:107]
    ds_read_b128 v[132:135], v3 offset:34816
    s_waitcnt lgkmcnt(8)
    v_mfma_f32_16x16x32_bf16 v[108:111], v[52:55], v[44:47], v[108:111]
    ds_read_b128 v[136:139], v3 offset:36864
    v_mfma_f32_16x16x32_bf16 v[100:103], v[52:55], v[40:43], v[100:103]
    ds_read_b128 v[140:143], v3 offset:38912
    v_mfma_f32_16x16x32_bf16 v[76:79], v[52:55], v[36:39], v[76:79]
    ds_read_b64_tr_b16 v[148:149], v5 offset:40960
    v_mfma_f32_16x16x32_bf16 v[68:71], v[52:55], v[32:35], v[68:71]
    ds_read_b64_tr_b16 v[150:151], v5 offset:41984
    s_waitcnt lgkmcnt(8)
    v_mfma_f32_16x16x32_bf16 v[80:83], v[56:59], v[32:35], v[80:83]
    ds_read_b64_tr_b16 v[152:153], v6 offset:40960
    v_mfma_f32_16x16x32_bf16 v[88:91], v[56:59], v[36:39], v[88:91]
    ds_read_b64_tr_b16 v[154:155], v6 offset:41984
    v_mfma_f32_16x16x32_bf16 v[112:115], v[56:59], v[40:43], v[112:115]
    ds_read_b64_tr_b16 v[156:157], v7 offset:40960
    v_mfma_f32_16x16x32_bf16 v[120:123], v[56:59], v[44:47], v[120:123]
    ds_read_b64_tr_b16 v[158:159], v7 offset:41984
    v_mfma_f32_16x16x32_bf16 v[124:127], v[60:63], v[44:47], v[124:127]
    v_mfma_f32_16x16x32_bf16 v[116:119], v[60:63], v[40:43], v[116:119]
    v_mfma_f32_16x16x32_bf16 v[92:95], v[60:63], v[36:39], v[92:95]
    v_mfma_f32_16x16x32_bf16 v[84:87], v[60:63], v[32:35], v[84:87]
    s_waitcnt lgkmcnt(6)
    v_mfma_f32_16x16x32_bf16 v[64:67], v[144:147], v[128:131], v[64:67]
    s_barrier
    v_xor_b32 v2, 0x10000, v2
    ds_read_b128 v[32:35], v2 offset:0
    v_mfma_f32_16x16x32_bf16 v[72:75], v[144:147], v[132:135], v[72:75]
    v_xor_b32 v4, 0x10000, v4
    ds_read_b64_tr_b16 v[48:49], v4 offset:0
    v_mfma_f32_16x16x32_bf16 v[96:99], v[144:147], v[136:139], v[96:99]
    ds_read_b64_tr_b16 v[50:51], v4 offset:1024
    v_mfma_f32_16x16x32_bf16 v[104:107], v[144:147], v[140:143], v[104:107]
    ds_read_b128 v[36:39], v2 offset:2048
    s_waitcnt lgkmcnt(8)
    v_mfma_f32_16x16x32_bf16 v[108:111], v[148:151], v[140:143], v[108:111]
    ds_read_b128 v[40:43], v2 offset:4096
    v_mfma_f32_16x16x32_bf16 v[100:103], v[148:151], v[136:139], v[100:103]
    ds_read_b128 v[44:47], v2 offset:6144
    v_mfma_f32_16x16x32_bf16 v[76:79], v[148:151], v[132:135], v[76:79]
    v_xor_b32 v5, 0x10000, v5
    ds_read_b64_tr_b16 v[52:53], v5 offset:0
    v_mfma_f32_16x16x32_bf16 v[68:71], v[148:151], v[128:131], v[68:71]
    ds_read_b64_tr_b16 v[54:55], v5 offset:1024
    s_waitcnt lgkmcnt(8)
    v_mfma_f32_16x16x32_bf16 v[80:83], v[152:155], v[128:131], v[80:83]
    v_xor_b32 v6, 0x10000, v6
    ds_read_b64_tr_b16 v[56:57], v6 offset:0
    v_mfma_f32_16x16x32_bf16 v[88:91], v[152:155], v[132:135], v[88:91]
    ds_read_b64_tr_b16 v[58:59], v6 offset:1024
    v_mfma_f32_16x16x32_bf16 v[112:115], v[152:155], v[136:139], v[112:115]
    v_xor_b32 v7, 0x10000, v7
    ds_read_b64_tr_b16 v[60:61], v7 offset:0
    v_mfma_f32_16x16x32_bf16 v[120:123], v[152:155], v[140:143], v[120:123]
    ds_read_b64_tr_b16 v[62:63], v7 offset:1024
    v_mfma_f32_16x16x32_bf16 v[124:127], v[156:159], v[140:143], v[124:127]
    v_xor_b32 v3, 0x10000, v3
    v_mfma_f32_16x16x32_bf16 v[116:119], v[156:159], v[136:139], v[116:119]
    v_mfma_f32_16x16x32_bf16 v[92:95], v[156:159], v[132:135], v[92:95]
    v_mfma_f32_16x16x32_bf16 v[84:87], v[156:159], v[128:131], v[84:87]
    s_sub_u32 s51, s51, 1
    s_cmp_lg_u32 s51, 0
    s_cbranch_scc1 gated_mix__mha_block__mixer_token_mlp__prompt_kernel_gl23
    s_setprio 3
    s_cmp_lt_u32 s47, 5
    s_cselect_b32 s52, 0x3ea52b5c, 1.0
    s_mov_b32 s53, s52
    v_lshlrev_b32 v2, 15, v9
    v_lshl_add_u32 v2, v8, 4, v2
    s_lshl_b32 s54, s47, 4
    s_lshl_b32 s55, s49, 3
    s_add_u32 s54, s54, s55
    s_lshl_b32 s54, s54, 15
    s_lshl_b32 s55, s46, 11
    s_add_u32 s54, s54, s55
    s_lshl_b32 s55, s48, 10
    s_add_u32 s54, s54, s55
    s_waitcnt lgkmcnt(0)
.p2align 3
    v_pk_mul_f32 v[64:65], v[64:65], s[52:53]
    v_pk_mul_f32 v[66:67], v[66:67], s[52:53]
    v_pk_mul_f32 v[72:73], v[72:73], s[52:53]
    v_pk_mul_f32 v[74:75], v[74:75], s[52:53]
    v_cvt_pk_bf16_f32 v32, v64, v65
    v_cvt_pk_bf16_f32 v33, v66, v67
    v_cvt_pk_bf16_f32 v34, v72, v73
    v_cvt_pk_bf16_f32 v35, v74, v75
    s_nop 1
    v_permlane16_swap_b32 v32, v34
    v_permlane16_swap_b32 v33, v35
    buffer_store_dwordx4 v[32:35], v2, s[24:27], s54 offen offset:0 sc1
.p2align 3
    v_pk_mul_f32 v[96:97], v[96:97], s[52:53]
    v_pk_mul_f32 v[98:99], v[98:99], s[52:53]
    v_pk_mul_f32 v[104:105], v[104:105], s[52:53]
    v_pk_mul_f32 v[106:107], v[106:107], s[52:53]
    v_cvt_pk_bf16_f32 v36, v96, v97
    v_cvt_pk_bf16_f32 v37, v98, v99
    v_cvt_pk_bf16_f32 v38, v104, v105
    v_cvt_pk_bf16_f32 v39, v106, v107
    s_nop 1
    v_permlane16_swap_b32 v36, v38
    v_permlane16_swap_b32 v37, v39
    buffer_store_dwordx4 v[36:39], v2, s[24:27], s54 offen offset:512 sc1
    s_add_u32 s54, s54, 65536
.p2align 3
    v_pk_mul_f32 v[68:69], v[68:69], s[52:53]
    v_pk_mul_f32 v[70:71], v[70:71], s[52:53]
    v_pk_mul_f32 v[76:77], v[76:77], s[52:53]
    v_pk_mul_f32 v[78:79], v[78:79], s[52:53]
    v_cvt_pk_bf16_f32 v40, v68, v69
    v_cvt_pk_bf16_f32 v41, v70, v71
    v_cvt_pk_bf16_f32 v42, v76, v77
    v_cvt_pk_bf16_f32 v43, v78, v79
    s_nop 1
    v_permlane16_swap_b32 v40, v42
    v_permlane16_swap_b32 v41, v43
    buffer_store_dwordx4 v[40:43], v2, s[24:27], s54 offen offset:0 sc1
.p2align 3
    v_pk_mul_f32 v[100:101], v[100:101], s[52:53]
    v_pk_mul_f32 v[102:103], v[102:103], s[52:53]
    v_pk_mul_f32 v[108:109], v[108:109], s[52:53]
    v_pk_mul_f32 v[110:111], v[110:111], s[52:53]
    v_cvt_pk_bf16_f32 v44, v100, v101
    v_cvt_pk_bf16_f32 v45, v102, v103
    v_cvt_pk_bf16_f32 v46, v108, v109
    v_cvt_pk_bf16_f32 v47, v110, v111
    s_nop 1
    v_permlane16_swap_b32 v44, v46
    v_permlane16_swap_b32 v45, v47
    buffer_store_dwordx4 v[44:47], v2, s[24:27], s54 offen offset:512 sc1
    s_add_u32 s54, s54, 65536
    s_barrier
.p2align 3
    v_pk_mul_f32 v[80:81], v[80:81], s[52:53]
    v_pk_mul_f32 v[82:83], v[82:83], s[52:53]
    v_pk_mul_f32 v[88:89], v[88:89], s[52:53]
    v_pk_mul_f32 v[90:91], v[90:91], s[52:53]
    v_cvt_pk_bf16_f32 v48, v80, v81
    v_cvt_pk_bf16_f32 v49, v82, v83
    v_cvt_pk_bf16_f32 v50, v88, v89
    v_cvt_pk_bf16_f32 v51, v90, v91
    s_nop 1
    v_permlane16_swap_b32 v48, v50
    v_permlane16_swap_b32 v49, v51
    buffer_store_dwordx4 v[48:51], v2, s[24:27], s54 offen offset:0 sc1
.p2align 3
    v_pk_mul_f32 v[112:113], v[112:113], s[52:53]
    v_pk_mul_f32 v[114:115], v[114:115], s[52:53]
    v_pk_mul_f32 v[120:121], v[120:121], s[52:53]
    v_pk_mul_f32 v[122:123], v[122:123], s[52:53]
    v_cvt_pk_bf16_f32 v52, v112, v113
    v_cvt_pk_bf16_f32 v53, v114, v115
    v_cvt_pk_bf16_f32 v54, v120, v121
    v_cvt_pk_bf16_f32 v55, v122, v123
    s_nop 1
    v_permlane16_swap_b32 v52, v54
    v_permlane16_swap_b32 v53, v55
    buffer_store_dwordx4 v[52:55], v2, s[24:27], s54 offen offset:512 sc1
    s_add_u32 s54, s54, 65536
.p2align 3
    v_pk_mul_f32 v[84:85], v[84:85], s[52:53]
    v_pk_mul_f32 v[86:87], v[86:87], s[52:53]
    v_pk_mul_f32 v[92:93], v[92:93], s[52:53]
    v_pk_mul_f32 v[94:95], v[94:95], s[52:53]
    v_cvt_pk_bf16_f32 v56, v84, v85
    v_cvt_pk_bf16_f32 v57, v86, v87
    v_cvt_pk_bf16_f32 v58, v92, v93
    v_cvt_pk_bf16_f32 v59, v94, v95
    s_nop 1
    v_permlane16_swap_b32 v56, v58
    v_permlane16_swap_b32 v57, v59
    buffer_store_dwordx4 v[56:59], v2, s[24:27], s54 offen offset:0 sc1
.p2align 3
    v_pk_mul_f32 v[116:117], v[116:117], s[52:53]
    v_pk_mul_f32 v[118:119], v[118:119], s[52:53]
    v_pk_mul_f32 v[124:125], v[124:125], s[52:53]
    v_pk_mul_f32 v[126:127], v[126:127], s[52:53]
    v_cvt_pk_bf16_f32 v60, v116, v117
    v_cvt_pk_bf16_f32 v61, v118, v119
    v_cvt_pk_bf16_f32 v62, v124, v125
    v_cvt_pk_bf16_f32 v63, v126, v127
    s_nop 1
    v_permlane16_swap_b32 v60, v62
    v_permlane16_swap_b32 v61, v63
    buffer_store_dwordx4 v[60:63], v2, s[24:27], s54 offen offset:512 sc1
    s_add_u32 s54, s54, 65536
    s_branch gated_mix__mha_block__mixer_token_mlp__prompt_kernel_qkv_pub
gated_mix__mha_block__mixer_token_mlp__prompt_kernel_qkv_v:
gated_mix__mha_block__mixer_token_mlp__prompt_kernel_gl24:
    s_waitcnt lgkmcnt(6)
    v_mfma_f32_16x16x32_bf16 v[64:67], v[32:35], v[48:51], v[64:67]
    ds_read_b128 v[128:131], v3 offset:0
    v_mfma_f32_16x16x32_bf16 v[72:75], v[36:39], v[48:51], v[72:75]
    ds_read_b64_tr_b16 v[144:145], v4 offset:8192
    v_mfma_f32_16x16x32_bf16 v[96:99], v[40:43], v[48:51], v[96:99]
    ds_read_b64_tr_b16 v[146:147], v4 offset:9216
    v_mfma_f32_16x16x32_bf16 v[104:107], v[44:47], v[48:51], v[104:107]
    ds_read_b128 v[132:135], v3 offset:2048
    s_waitcnt lgkmcnt(8)
    v_mfma_f32_16x16x32_bf16 v[108:111], v[44:47], v[52:55], v[108:111]
    ds_read_b128 v[136:139], v3 offset:4096
    v_mfma_f32_16x16x32_bf16 v[100:103], v[40:43], v[52:55], v[100:103]
    ds_read_b128 v[140:143], v3 offset:6144
    v_mfma_f32_16x16x32_bf16 v[76:79], v[36:39], v[52:55], v[76:79]
    ds_read_b64_tr_b16 v[148:149], v5 offset:8192
    v_mfma_f32_16x16x32_bf16 v[68:71], v[32:35], v[52:55], v[68:71]
    ds_read_b64_tr_b16 v[150:151], v5 offset:9216
    s_waitcnt lgkmcnt(8)
    v_mfma_f32_16x16x32_bf16 v[80:83], v[32:35], v[56:59], v[80:83]
    ds_read_b64_tr_b16 v[152:153], v6 offset:8192
    v_mfma_f32_16x16x32_bf16 v[88:91], v[36:39], v[56:59], v[88:91]
    ds_read_b64_tr_b16 v[154:155], v6 offset:9216
    v_mfma_f32_16x16x32_bf16 v[112:115], v[40:43], v[56:59], v[112:115]
    ds_read_b64_tr_b16 v[156:157], v7 offset:8192
    v_mfma_f32_16x16x32_bf16 v[120:123], v[44:47], v[56:59], v[120:123]
    ds_read_b64_tr_b16 v[158:159], v7 offset:9216
    v_mfma_f32_16x16x32_bf16 v[124:127], v[44:47], v[60:63], v[124:127]
    v_mfma_f32_16x16x32_bf16 v[116:119], v[40:43], v[60:63], v[116:119]
    v_mfma_f32_16x16x32_bf16 v[92:95], v[36:39], v[60:63], v[92:95]
    v_mfma_f32_16x16x32_bf16 v[84:87], v[32:35], v[60:63], v[84:87]
    s_waitcnt lgkmcnt(6)
    v_mfma_f32_16x16x32_bf16 v[64:67], v[128:131], v[144:147], v[64:67]
    s_barrier
    ds_read_b128 v[32:35], v2 offset:32768
    v_mfma_f32_16x16x32_bf16 v[72:75], v[132:135], v[144:147], v[72:75]
    ds_read_b64_tr_b16 v[48:49], v4 offset:32768
    v_mfma_f32_16x16x32_bf16 v[96:99], v[136:139], v[144:147], v[96:99]
    ds_read_b64_tr_b16 v[50:51], v4 offset:33792
    v_mfma_f32_16x16x32_bf16 v[104:107], v[140:143], v[144:147], v[104:107]
    ds_read_b128 v[36:39], v2 offset:34816
    s_waitcnt lgkmcnt(8)
    v_mfma_f32_16x16x32_bf16 v[108:111], v[140:143], v[148:151], v[108:111]
    ds_read_b128 v[40:43], v2 offset:36864
    v_mfma_f32_16x16x32_bf16 v[100:103], v[136:139], v[148:151], v[100:103]
    ds_read_b128 v[44:47], v2 offset:38912
    v_mfma_f32_16x16x32_bf16 v[76:79], v[132:135], v[148:151], v[76:79]
    ds_read_b64_tr_b16 v[52:53], v5 offset:32768
    v_mfma_f32_16x16x32_bf16 v[68:71], v[128:131], v[148:151], v[68:71]
    ds_read_b64_tr_b16 v[54:55], v5 offset:33792
    s_waitcnt lgkmcnt(8)
    v_mfma_f32_16x16x32_bf16 v[80:83], v[128:131], v[152:155], v[80:83]
    ds_read_b64_tr_b16 v[56:57], v6 offset:32768
    v_mfma_f32_16x16x32_bf16 v[88:91], v[132:135], v[152:155], v[88:91]
    ds_read_b64_tr_b16 v[58:59], v6 offset:33792
    v_mfma_f32_16x16x32_bf16 v[112:115], v[136:139], v[152:155], v[112:115]
    ds_read_b64_tr_b16 v[60:61], v7 offset:32768
    v_mfma_f32_16x16x32_bf16 v[120:123], v[140:143], v[152:155], v[120:123]
    ds_read_b64_tr_b16 v[62:63], v7 offset:33792
    v_mfma_f32_16x16x32_bf16 v[124:127], v[140:143], v[156:159], v[124:127]
    v_mfma_f32_16x16x32_bf16 v[116:119], v[136:139], v[156:159], v[116:119]
    v_mfma_f32_16x16x32_bf16 v[92:95], v[132:135], v[156:159], v[92:95]
    v_mfma_f32_16x16x32_bf16 v[84:87], v[128:131], v[156:159], v[84:87]
    s_waitcnt lgkmcnt(6)
    v_mfma_f32_16x16x32_bf16 v[64:67], v[32:35], v[48:51], v[64:67]
    ds_read_b128 v[128:131], v3 offset:32768
    v_mfma_f32_16x16x32_bf16 v[72:75], v[36:39], v[48:51], v[72:75]
    ds_read_b64_tr_b16 v[144:145], v4 offset:40960
    v_mfma_f32_16x16x32_bf16 v[96:99], v[40:43], v[48:51], v[96:99]
    ds_read_b64_tr_b16 v[146:147], v4 offset:41984
    v_mfma_f32_16x16x32_bf16 v[104:107], v[44:47], v[48:51], v[104:107]
    ds_read_b128 v[132:135], v3 offset:34816
    s_waitcnt lgkmcnt(8)
    v_mfma_f32_16x16x32_bf16 v[108:111], v[44:47], v[52:55], v[108:111]
    ds_read_b128 v[136:139], v3 offset:36864
    v_mfma_f32_16x16x32_bf16 v[100:103], v[40:43], v[52:55], v[100:103]
    ds_read_b128 v[140:143], v3 offset:38912
    v_mfma_f32_16x16x32_bf16 v[76:79], v[36:39], v[52:55], v[76:79]
    ds_read_b64_tr_b16 v[148:149], v5 offset:40960
    v_mfma_f32_16x16x32_bf16 v[68:71], v[32:35], v[52:55], v[68:71]
    ds_read_b64_tr_b16 v[150:151], v5 offset:41984
    s_waitcnt lgkmcnt(8)
    v_mfma_f32_16x16x32_bf16 v[80:83], v[32:35], v[56:59], v[80:83]
    ds_read_b64_tr_b16 v[152:153], v6 offset:40960
    v_mfma_f32_16x16x32_bf16 v[88:91], v[36:39], v[56:59], v[88:91]
    ds_read_b64_tr_b16 v[154:155], v6 offset:41984
    v_mfma_f32_16x16x32_bf16 v[112:115], v[40:43], v[56:59], v[112:115]
    ds_read_b64_tr_b16 v[156:157], v7 offset:40960
    v_mfma_f32_16x16x32_bf16 v[120:123], v[44:47], v[56:59], v[120:123]
    ds_read_b64_tr_b16 v[158:159], v7 offset:41984
    v_mfma_f32_16x16x32_bf16 v[124:127], v[44:47], v[60:63], v[124:127]
    v_mfma_f32_16x16x32_bf16 v[116:119], v[40:43], v[60:63], v[116:119]
    v_mfma_f32_16x16x32_bf16 v[92:95], v[36:39], v[60:63], v[92:95]
    v_mfma_f32_16x16x32_bf16 v[84:87], v[32:35], v[60:63], v[84:87]
    s_waitcnt lgkmcnt(6)
    v_mfma_f32_16x16x32_bf16 v[64:67], v[128:131], v[144:147], v[64:67]
    s_barrier
    v_xor_b32 v2, 0x10000, v2
    ds_read_b128 v[32:35], v2 offset:0
    v_mfma_f32_16x16x32_bf16 v[72:75], v[132:135], v[144:147], v[72:75]
    v_xor_b32 v4, 0x10000, v4
    ds_read_b64_tr_b16 v[48:49], v4 offset:0
    v_mfma_f32_16x16x32_bf16 v[96:99], v[136:139], v[144:147], v[96:99]
    ds_read_b64_tr_b16 v[50:51], v4 offset:1024
    v_mfma_f32_16x16x32_bf16 v[104:107], v[140:143], v[144:147], v[104:107]
    ds_read_b128 v[36:39], v2 offset:2048
    s_waitcnt lgkmcnt(8)
    v_mfma_f32_16x16x32_bf16 v[108:111], v[140:143], v[148:151], v[108:111]
    ds_read_b128 v[40:43], v2 offset:4096
    v_mfma_f32_16x16x32_bf16 v[100:103], v[136:139], v[148:151], v[100:103]
    ds_read_b128 v[44:47], v2 offset:6144
    v_mfma_f32_16x16x32_bf16 v[76:79], v[132:135], v[148:151], v[76:79]
    v_xor_b32 v5, 0x10000, v5
    ds_read_b64_tr_b16 v[52:53], v5 offset:0
    v_mfma_f32_16x16x32_bf16 v[68:71], v[128:131], v[148:151], v[68:71]
    ds_read_b64_tr_b16 v[54:55], v5 offset:1024
    s_waitcnt lgkmcnt(8)
    v_mfma_f32_16x16x32_bf16 v[80:83], v[128:131], v[152:155], v[80:83]
    v_xor_b32 v6, 0x10000, v6
    ds_read_b64_tr_b16 v[56:57], v6 offset:0
    v_mfma_f32_16x16x32_bf16 v[88:91], v[132:135], v[152:155], v[88:91]
    ds_read_b64_tr_b16 v[58:59], v6 offset:1024
    v_mfma_f32_16x16x32_bf16 v[112:115], v[136:139], v[152:155], v[112:115]
    v_xor_b32 v7, 0x10000, v7
    ds_read_b64_tr_b16 v[60:61], v7 offset:0
    v_mfma_f32_16x16x32_bf16 v[120:123], v[140:143], v[152:155], v[120:123]
    ds_read_b64_tr_b16 v[62:63], v7 offset:1024
    v_mfma_f32_16x16x32_bf16 v[124:127], v[140:143], v[156:159], v[124:127]
    v_xor_b32 v3, 0x10000, v3
    v_mfma_f32_16x16x32_bf16 v[116:119], v[136:139], v[156:159], v[116:119]
    v_mfma_f32_16x16x32_bf16 v[92:95], v[132:135], v[156:159], v[92:95]
    v_mfma_f32_16x16x32_bf16 v[84:87], v[128:131], v[156:159], v[84:87]
    s_sub_u32 s51, s51, 1
    s_cmp_lg_u32 s51, 0
    s_cbranch_scc1 gated_mix__mha_block__mixer_token_mlp__prompt_kernel_gl24
    s_setprio 3
    s_sub_u32 s54, s47, 10
    s_lshl_b32 s54, s54, 7
    s_lshl_b32 s55, s49, 6
    s_add_u32 s54, s54, s55
    v_add_u32 v4, s54, v8
    v_mul_u32_u24 v6, 320, v9
    v_mul_u32_u24 v5, 3277, v4
    v_lshrrev_b32 v5, 16, v5
    v_mul_u32_u24 v2, 81600, v5
    v_lshl_add_u32 v2, v4, 4, v2
    v_add_u32 v2, v2, v6
    v_add_u32 v4, 32, v4
    v_mul_u32_u24 v5, 3277, v4
    v_lshrrev_b32 v5, 16, v5
    v_mul_u32_u24 v3, 81600, v5
    v_lshl_add_u32 v3, v4, 4, v3
    v_add_u32 v3, v3, v6
    v_add_u32 v4, 32, v4
    s_lshl_b32 s54, s46, 1
    s_add_u32 s54, s54, s48
    s_mul_i32 s54, s54, 2560
    s_add_u32 s54, s54, 5242880
    s_waitcnt lgkmcnt(0)
.p2align 3
    v_cvt_pk_bf16_f32 v32, v64, v65
    v_cvt_pk_bf16_f32 v33, v66, v67
    v_cvt_pk_bf16_f32 v34, v68, v69
    v_cvt_pk_bf16_f32 v35, v70, v71
    s_nop 1
    v_permlane16_swap_b32 v32, v34
    v_permlane16_swap_b32 v33, v35
    buffer_store_dwordx4 v[32:35], v2, s[24:27], s54 offen offset:0 sc1
.p2align 3
    v_cvt_pk_bf16_f32 v36, v80, v81
    v_cvt_pk_bf16_f32 v37, v82, v83
    v_cvt_pk_bf16_f32 v38, v84, v85
    v_cvt_pk_bf16_f32 v39, v86, v87
    s_nop 1
    v_permlane16_swap_b32 v36, v38
    v_permlane16_swap_b32 v37, v39
    buffer_store_dwordx4 v[36:39], v3, s[24:27], s54 offen offset:0 sc1
.p2align 3
    v_cvt_pk_bf16_f32 v40, v72, v73
    v_cvt_pk_bf16_f32 v41, v74, v75
    v_cvt_pk_bf16_f32 v42, v76, v77
    v_cvt_pk_bf16_f32 v43, v78, v79
    s_nop 1
    v_permlane16_swap_b32 v40, v42
    v_permlane16_swap_b32 v41, v43
    buffer_store_dwordx4 v[40:43], v2, s[24:27], s54 offen offset:640 sc1
.p2align 3
    v_cvt_pk_bf16_f32 v44, v88, v89
    v_cvt_pk_bf16_f32 v45, v90, v91
    v_cvt_pk_bf16_f32 v46, v92, v93
    v_cvt_pk_bf16_f32 v47, v94, v95
    s_nop 1
    v_permlane16_swap_b32 v44, v46
    v_permlane16_swap_b32 v45, v47
    buffer_store_dwordx4 v[44:47], v3, s[24:27], s54 offen offset:640 sc1
    s_barrier
.p2align 3
    v_cvt_pk_bf16_f32 v48, v96, v97
    v_cvt_pk_bf16_f32 v49, v98, v99
    v_cvt_pk_bf16_f32 v50, v100, v101
    v_cvt_pk_bf16_f32 v51, v102, v103
    s_nop 1
    v_permlane16_swap_b32 v48, v50
    v_permlane16_swap_b32 v49, v51
    buffer_store_dwordx4 v[48:51], v2, s[24:27], s54 offen offset:1280 sc1
.p2align 3
    v_cvt_pk_bf16_f32 v52, v112, v113
    v_cvt_pk_bf16_f32 v53, v114, v115
    v_cvt_pk_bf16_f32 v54, v116, v117
    v_cvt_pk_bf16_f32 v55, v118, v119
    s_nop 1
    v_permlane16_swap_b32 v52, v54
    v_permlane16_swap_b32 v53, v55
    buffer_store_dwordx4 v[52:55], v3, s[24:27], s54 offen offset:1280 sc1
.p2align 3
    v_cvt_pk_bf16_f32 v56, v104, v105
    v_cvt_pk_bf16_f32 v57, v106, v107
    v_cvt_pk_bf16_f32 v58, v108, v109
    v_cvt_pk_bf16_f32 v59, v110, v111
    s_nop 1
    v_permlane16_swap_b32 v56, v58
    v_permlane16_swap_b32 v57, v59
    buffer_store_dwordx4 v[56:59], v2, s[24:27], s54 offen offset:1920 sc1
.p2align 3
    v_cvt_pk_bf16_f32 v60, v120, v121
    v_cvt_pk_bf16_f32 v61, v122, v123
    v_cvt_pk_bf16_f32 v62, v124, v125
    v_cvt_pk_bf16_f32 v63, v126, v127
    s_nop 1
    v_permlane16_swap_b32 v60, v62
    v_permlane16_swap_b32 v61, v63
    buffer_store_dwordx4 v[60:63], v3, s[24:27], s54 offen offset:1920 sc1
gated_mix__mha_block__mixer_token_mlp__prompt_kernel_qkv_pub:
    s_barrier
    s_mov_b64 exec, s[56:57]
    s_waitcnt vmcnt(0)
    buffer_atomic_add v12, v13, s[24:27], s58 offen sc1
    s_mov_b64 exec, -1
    s_barrier
    s_barrier
gated_mix__mha_block__mixer_token_mlp__prompt_kernel_att:
    s_setprio 3
    s_lshl_b32 s48, s43, 2
    s_and_b32 s57, s44, 3
    s_add_u32 s48, s48, s57
    s_lshr_b32 s49, s44, 2
    s_lshr_b32 s50, s48, 1
    s_and_b32 s51, s48, 1
    s_mov_b32 s58, -1
    s_mov_b32 s59, 0xffff
    s_mov_b32 s60, 0xffefffff
    s_mov_b32 s61, 0x1ff
    s_mul_i32 s62, s50, 163840
    s_add_u32 s62, s62, 2621440
    s_mul_i32 s63, s48, 81920
    s_add_u32 s63, s63, 5242880
    s_mul_i32 s54, s42, 768
    s_add_u32 s54, s54, 117504
    s_mul_i32 s55, s42, 672
    s_add_u32 s55, s55, 123648
    s_lshl_b32 s100, s49, 8
    s_and_b32 s57, s42, 3
    s_lshl_b32 s57, s57, 6
    s_add_u32 s100, s100, s57
    s_lshr_b32 s56, s42, 2
    s_lshl_b32 s57, s56, 5
    s_add_u32 s100, s100, s57
    s_lshl_b32 s70, s100, 4
    s_add_u32 s70, s70, s62
    s_sub_u32 s70, s70, 2621440
    s_lshl_b32 s71, s100, 2
    s_add_u32 s71, s71, 15204352
    s_mov_b32 s52, s62
    s_mov_b32 s53, s63
    v_mov_b32 v86, 163636
    v_xor_b32 v84, s56, v24
    v_lshl_add_u32 v84, v84, 9, v26
    s_xor_b32 s67, s70, 512
    s_andn2_b32 s68, s70, 512
    s_cmp_ge_u32 s42, 4
    s_cbranch_scc1 gated_mix__mha_block__mixer_token_mlp__prompt_kernel_a26
    s_cmp_lg_u32 s42, 0
    s_cbranch_scc1 gated_mix__mha_block__mixer_token_mlp__prompt_kernel_a25
    s_mul_i32 s65, s49, 128
    s_add_u32 s65, s65, 15285248
    v_mul_u32_u24 v87, 4, v23
    s_mov_b32 s64, 15319040
    s_barrier
    s_cmp_lg_u32 s47, 15
    s_cbranch_scc1 gated_mix__mha_block__mixer_token_mlp__prompt_kernel_a27
    s_mov_b32 s45, 200000
gated_mix__mha_block__mixer_token_mlp__prompt_kernel_apoll33:
    s_mov_b64 exec, 3
    v_mov_b32 v89, 0
    buffer_atomic_add v89, v28, s[24:27], s64 offen sc0 sc1
gated_mix__mha_block__mixer_token_mlp__prompt_kernel_apollc35:
    s_waitcnt vmcnt(0)
    v_cmp_gt_u32 vcc, 1, v89
    s_cbranch_vccz gated_mix__mha_block__mixer_token_mlp__prompt_kernel_apolld34
    s_sleep 16
    s_sub_u32 s45, s45, 1
    s_cbranch_scc0 gated_mix__mha_block__mixer_token_mlp__prompt_kernel_apoll33
gated_mix__mha_block__mixer_token_mlp__prompt_kernel_apolld34:
    s_mov_b64 exec, -1
gated_mix__mha_block__mixer_token_mlp__prompt_kernel_a27:
    buffer_load_dword v90, v87, s[24:27], s65 offen offset:0 sc1
    s_mov_b64 exec, 7
    v_mov_b32 v89, 0
    buffer_atomic_add v89, v28, s[24:27], s64 offen sc0 sc1
    s_mov_b64 exec, -1
    s_barrier
    s_mov_b32 s45, 200000
    s_waitcnt vmcnt(1)
    s_branch gated_mix__mha_block__mixer_token_mlp__prompt_kernel_pollc38
gated_mix__mha_block__mixer_token_mlp__prompt_kernel_poll36:
    buffer_load_dword v90, v87, s[24:27], s65 offen offset:0 sc1
    s_waitcnt vmcnt(0)
gated_mix__mha_block__mixer_token_mlp__prompt_kernel_pollc38:
    v_cmp_eq_u32 vcc, 0, v90
    s_cbranch_vccz gated_mix__mha_block__mixer_token_mlp__prompt_kernel_polld37
    s_sleep 4
    s_sub_u32 s45, s45, 1
    s_cbranch_scc0 gated_mix__mha_block__mixer_token_mlp__prompt_kernel_poll36
gated_mix__mha_block__mixer_token_mlp__prompt_kernel_polld37:
    s_mov_b64 exec, 7
    s_waitcnt vmcnt(0)
    v_cmp_gt_u32 vcc, v29, v89
    s_cbranch_vccnz gated_mix__mha_block__mixer_token_mlp__prompt_kernel_a29
    s_mov_b64 exec, 1
    v_mov_b32 v85, 1
    ds_write_b32 v86, v85
    s_mov_b64 exec, -1
    s_branch gated_mix__mha_block__mixer_token_mlp__prompt_kernel_a30
gated_mix__mha_block__mixer_token_mlp__prompt_kernel_a29:
    s_mov_b64 exec, 7
    v_mov_b32 v89, 0
    buffer_atomic_add v89, v28, s[24:27], s64 offen sc0 sc1
    s_mov_b64 exec, -1
    s_barrier
    s_mov_b32 s45, 200000
    s_mov_b64 exec, 7
    s_branch gated_mix__mha_block__mixer_token_mlp__prompt_kernel_apollc41
gated_mix__mha_block__mixer_token_mlp__prompt_kernel_apoll39:
    s_mov_b64 exec, 7
    v_mov_b32 v89, 0
    buffer_atomic_add v89, v28, s[24:27], s64 offen sc0 sc1
gated_mix__mha_block__mixer_token_mlp__prompt_kernel_apollc41:
    s_waitcnt vmcnt(0)
    v_cmp_gt_u32 vcc, v29, v89
    s_cbranch_vccz gated_mix__mha_block__mixer_token_mlp__prompt_kernel_apolld40
    s_sleep 2
    s_sub_u32 s45, s45, 1
    s_cbranch_scc0 gated_mix__mha_block__mixer_token_mlp__prompt_kernel_apoll39
gated_mix__mha_block__mixer_token_mlp__prompt_kernel_apolld40:
    s_mov_b64 exec, -1
    s_mov_b64 exec, 1
    v_mov_b32 v85, 1
    ds_write_b32 v86, v85
    s_mov_b64 exec, -1
    s_add_u32 m0, s54, 23040
    s_mov_b64 exec, s[58:59]
    buffer_load_dwordx4 v17, s[24:27], s52 offen sc1 lds
    s_add_u32 m0, s55, 23040
    s_mov_b64 exec, s[60:61]
    buffer_load_dwordx4 v18, s[24:27], s53 offen sc1 lds
    s_mov_b64 exec, -1
    s_add_u32 s52, s52, 2048
    s_add_u32 s53, s53, 5120
    buffer_load_dwordx4 v[8:11], v25, s[24:27], s70 offen sc1
    buffer_load_dwordx2 v[12:13], v84, s[24:27], s68 offen sc1
    buffer_load_dwordx4 v[144:147], v25, s[24:27], s67 offen sc1
    s_setprio 2
    s_add_u32 m0, s54, 34560
    s_mov_b64 exec, s[58:59]
    buffer_load_dwordx4 v17, s[24:27], s52 offen sc1 lds
    s_add_u32 m0, s55, 34560
    s_mov_b64 exec, s[60:61]
    buffer_load_dwordx4 v18, s[24:27], s53 offen sc1 lds
    s_mov_b64 exec, -1
    s_add_u32 s52, s52, 2048
    s_add_u32 s53, s53, 5120
    s_branch gated_mix__mha_block__mixer_token_mlp__prompt_kernel_a31
gated_mix__mha_block__mixer_token_mlp__prompt_kernel_a25:
    s_barrier
    s_barrier
gated_mix__mha_block__mixer_token_mlp__prompt_kernel_a26:
gated_mix__mha_block__mixer_token_mlp__prompt_kernel_a30:
    s_waitcnt vmcnt(0)
    s_barrier
    s_mov_b32 s45, 800000
gated_mix__mha_block__mixer_token_mlp__prompt_kernel_spin42:
    ds_read_b32 v87, v86 offset:0
    s_waitcnt lgkmcnt(0)
    v_cmp_gt_u32 vcc, 1, v87
    s_cbranch_vccz gated_mix__mha_block__mixer_token_mlp__prompt_kernel_spind43
    s_sleep 0
    s_sub_u32 s45, s45, 1
    s_cbranch_scc0 gated_mix__mha_block__mixer_token_mlp__prompt_kernel_spin42
gated_mix__mha_block__mixer_token_mlp__prompt_kernel_spind43:
    s_add_u32 m0, s54, 23040
    s_mov_b64 exec, s[58:59]
    buffer_load_dwordx4 v17, s[24:27], s52 offen sc1 lds
    s_add_u32 m0, s55, 23040
    s_mov_b64 exec, s[60:61]
    buffer_load_dwordx4 v18, s[24:27], s53 offen sc1 lds
    s_mov_b64 exec, -1
    s_add_u32 s52, s52, 2048
    s_add_u32 s53, s53, 5120
    buffer_load_dwordx4 v[8:11], v25, s[24:27], s70 offen sc1
    buffer_load_dwordx2 v[12:13], v84, s[24:27], s68 offen sc1
    buffer_load_dwordx4 v[144:147], v25, s[24:27], s67 offen sc1
    s_setprio 2
    s_add_u32 m0, s54, 34560
    s_mov_b64 exec, s[58:59]
    buffer_load_dwordx4 v17, s[24:27], s52 offen sc1 lds
    s_add_u32 m0, s55, 34560
    s_mov_b64 exec, s[60:61]
    buffer_load_dwordx4 v18, s[24:27], s53 offen sc1 lds
    s_mov_b64 exec, -1
    s_add_u32 s52, s52, 2048
    s_add_u32 s53, s53, 5120
    s_branch gated_mix__mha_block__mixer_token_mlp__prompt_kernel_a31
gated_mix__mha_block__mixer_token_mlp__prompt_kernel_a28:
    s_add_u32 m0, s54, 23040
    s_mov_b64 exec, s[58:59]
    buffer_load_dwordx4 v17, s[24:27], s52 offen sc1 lds
    s_add_u32 m0, s55, 23040
    s_mov_b64 exec, s[60:61]
    buffer_load_dwordx4 v18, s[24:27], s53 offen sc1 lds
    s_mov_b64 exec, -1
    s_add_u32 s52, s52, 2048
    s_add_u32 s53, s53, 5120
    buffer_load_dwordx4 v[8:11], v25, s[24:27], s70 offen sc1
    buffer_load_dwordx2 v[12:13], v84, s[24:27], s68 offen sc1
    buffer_load_dwordx4 v[144:147], v25, s[24:27], s67 offen sc1
    s_setprio 2
    s_add_u32 m0, s54, 34560
    s_mov_b64 exec, s[58:59]
    buffer_load_dwordx4 v17, s[24:27], s52 offen sc1 lds
    s_add_u32 m0, s55, 34560
    s_mov_b64 exec, s[60:61]
    buffer_load_dwordx4 v18, s[24:27], s53 offen sc1 lds
    s_mov_b64 exec, -1
    s_add_u32 s52, s52, 2048
    s_add_u32 s53, s53, 5120
    s_waitcnt vmcnt(7)
    s_barrier
gated_mix__mha_block__mixer_token_mlp__prompt_kernel_a31:
    s_cmp_lg_u32 s42, 1
    s_cbranch_scc1 gated_mix__mha_block__mixer_token_mlp__prompt_kernel_a32
    v_mov_b32 v88, 0x3f803f80
    v_mov_b32 v89, 0x3f803f80
    v_mov_b32 v90, 0x3f803f80
    v_mov_b32 v91, 0x3f803f80
    ds_write_b128 v28, v[88:91]
gated_mix__mha_block__mixer_token_mlp__prompt_kernel_a32:
    v_pk_mov_b32 v[64:65], 0, 0
    v_pk_mov_b32 v[128:129], 0, 0
    v_pk_mov_b32 v[66:67], 0, 0
    v_pk_mov_b32 v[130:131], 0, 0
    v_pk_mov_b32 v[68:69], 0, 0
    v_pk_mov_b32 v[132:133], 0, 0
    v_pk_mov_b32 v[70:71], 0, 0
    v_pk_mov_b32 v[134:135], 0, 0
    v_pk_mov_b32 v[72:73], 0, 0
    v_pk_mov_b32 v[136:137], 0, 0
    v_pk_mov_b32 v[74:75], 0, 0
    v_pk_mov_b32 v[138:139], 0, 0
    v_pk_mov_b32 v[76:77], 0, 0
    v_pk_mov_b32 v[140:141], 0, 0
    v_pk_mov_b32 v[78:79], 0, 0
    v_pk_mov_b32 v[142:143], 0, 0
    v_pk_mov_b32 v[120:121], 0, 0
    v_pk_mov_b32 v[122:123], 0, 0
    v_pk_mov_b32 v[124:125], 0, 0
    v_pk_mov_b32 v[126:127], 0, 0
    v_pk_mov_b32 v[160:161], 0, 0
    v_pk_mov_b32 v[162:163], 0, 0
    v_pk_mov_b32 v[148:149], 0, 0
    s_mul_i32 s64, s42, 3328
    s_add_u32 s64, s64, 102400
    v_lshlrev_b32 v81, 4, v0
    s_xor_b32 s65, s42, 4
    v_add_u32 v80, s64, v81
    v_lshl_add_u32 v85, v0, 2, s64
    s_mul_i32 s64, s65, 3328
    s_add_u32 s64, s64, 102400
    v_add_u32 v81, s64, v81
    v_lshl_add_u32 v86, v0, 2, s64
    s_lshl_b32 s65, s65, 2
    s_add_u32 s65, s65, 163584
    v_mov_b32 v82, s65
    v_lshlrev_b32 v92, 4, v23
    v_lshl_add_u32 v83, v24, 15, v92
    v_cmp_eq_u32 s[72:73], 0, v24
    v_mov_b32 v93, 0x5d800000
    v_mov_b32 v94, 0
    v_mov_b32 v95, 1
    s_lshl_b32 s64, s48, 16
    s_lshl_b32 s65, s100, 4
    s_add_u32 s65, s65, 12582912
    s_add_u32 s64, s64, s65
    s_lshl_b32 s65, s48, 14
    s_lshl_b32 s57, s100, 3
    s_add_u32 s65, s65, s57
    s_add_u32 s65, s65, 14680064
    v_lshlrev_b32 v92, 3, v23
    s_lshl_b32 s66, s100, 3
    s_add_u32 s66, s66, 15302656
    s_mov_b32 s70, 0x30800000
    s_mov_b32 s3, 2
    s_waitcnt vmcnt(5) lgkmcnt(0)
    ds_write_b32 v20, v22
    s_add_u32 m0, s54, 0
    s_mov_b64 exec, s[58:59]
    buffer_load_dwordx4 v17, s[24:27], s52 offen sc1 lds
    s_add_u32 m0, s55, 0
    s_mov_b64 exec, s[60:61]
    buffer_load_dwordx4 v18, s[24:27], s53 offen sc1 lds
    s_mov_b64 exec, -1
    s_add_u32 s52, s52, 2048
    s_add_u32 s53, s53, 5120
    buffer_load_dword v31, v27, s[24:27], s71 offen sc1
    v_add_u32 v22, 1, v22
    s_waitcnt vmcnt(5)
    v_permlane32_swap_b32 v12, v148
    v_permlane32_swap_b32 v13, v149
    s_mov_b32 s45, 800000
gated_mix__mha_block__mixer_token_mlp__prompt_kernel_spin44:
    ds_read_b32 v30, v21 offset:0
    s_waitcnt lgkmcnt(0)
    v_cmp_gt_u32 vcc, 1, v30
    s_cbranch_vccz gated_mix__mha_block__mixer_token_mlp__prompt_kernel_spind45
    s_sleep 0
    s_sub_u32 s45, s45, 1
    s_cbranch_scc0 gated_mix__mha_block__mixer_token_mlp__prompt_kernel_spin44
gated_mix__mha_block__mixer_token_mlp__prompt_kernel_spind45:
    ds_read_b128 v[152:155], v14 offset:23040
    ds_read_b64 v[150:151], v15 offset:23040
    ds_read_b128 v[156:159], v16 offset:23040
    s_waitcnt lgkmcnt(1)
    v_mfma_f32_32x32x16_bf16 v[32:47], v[152:155], v[144:147], 0
    v_mfma_f32_32x32x8_bf16 v[32:47], v[150:151], v[148:149], v[32:47]
    v_mfma_f32_32x32x16_bf16 v[48:63], v[152:155], v[8:11], 0
    ds_read_b128 v[152:155], v14 offset:24576
    v_mfma_f32_32x32x8_bf16 v[48:63], v[150:151], v[12:13], v[48:63]
    ds_read_b64 v[150:151], v15 offset:24576
    s_waitcnt vmcnt(3)
    ds_write_b32 v20, v22
    s_mov_b32 s69, 4
    v_add_u32 v22, 1, v22
    s_nop 3
    s_cmp_ge_u32 s42, 4
    s_cbranch_scc1 gated_mix__mha_block__mixer_token_mlp__prompt_kernel_young46
    s_setprio 1
.p2align 6
gated_mix__mha_block__mixer_token_mlp__prompt_kernel_attl48:
    v_exp_f32 v32, v32
    v_exp_f32 v33, v33
    v_smfmac_f32_32x32x32_bf16 v[64:79], v[160:163], v[120:127], v19
    ds_read_b128 v[160:163], v16 offset:23712
    v_exp_f32 v34, v34
    v_exp_f32 v35, v35
    v_exp_f32 v36, v36
    v_exp_f32 v37, v37
    s_waitcnt lgkmcnt(1)
    v_mfma_f32_32x32x16_bf16 v[96:111], v[152:155], v[144:147], 0
    v_exp_f32 v38, v38
    v_exp_f32 v39, v39
    v_exp_f32 v40, v40
    v_exp_f32 v41, v41
    v_mfma_f32_32x32x8_bf16 v[96:111], v[150:151], v[148:149], v[96:111]
    ds_read_b32 v30, v21
    v_exp_f32 v42, v42
    v_exp_f32 v43, v43
    v_exp_f32 v44, v44
    v_exp_f32 v45, v45
    v_smfmac_f32_32x32x32_bf16 v[128:143], v[156:159], v[32:39], v19
    v_exp_f32 v46, v46
    v_exp_f32 v47, v47
    v_exp_f32 v48, v48
    v_exp_f32 v49, v49
    s_waitcnt lgkmcnt(0)
    v_smfmac_f32_32x32x32_bf16 v[128:143], v[160:163], v[40:47], v19
    v_cmp_gt_u32 vcc, s3, v30
    s_cbranch_vccnz gated_mix__mha_block__mixer_token_mlp__prompt_kernel_ool49
gated_mix__mha_block__mixer_token_mlp__prompt_kernel_back50:
    v_exp_f32 v50, v50
    v_exp_f32 v51, v51
    v_exp_f32 v52, v52
    v_exp_f32 v53, v53
    v_mfma_f32_32x32x16_bf16 v[112:127], v[152:155], v[8:11], 0
    ds_read_b128 v[152:155], v14 offset:34560
    v_exp_f32 v54, v54
    v_exp_f32 v55, v55
    v_exp_f32 v56, v56
    v_exp_f32 v57, v57
    v_mfma_f32_32x32x8_bf16 v[112:127], v[150:151], v[12:13], v[112:127]
    ds_read_b64 v[150:151], v15 offset:34560
    s_add_u32 m0, s54, 11520
    s_mov_b64 exec, s[58:59]
    buffer_load_dwordx4 v17, s[24:27], s52 offen sc1 lds
    s_add_u32 m0, s55, 11520
    s_mov_b64 exec, s[60:61]
    buffer_load_dwordx4 v18, s[24:27], s53 offen sc1 lds
    s_mov_b64 exec, -1
    s_add_u32 s52, s52, 2048
    s_add_u32 s53, s53, 5120
    s_add_u32 s3, s3, 1
    v_exp_f32 v58, v58
    v_exp_f32 v59, v59
    v_exp_f32 v60, v60
    v_exp_f32 v61, v61
    v_smfmac_f32_32x32x32_bf16 v[64:79], v[156:159], v[48:55], v19
    ds_read_b128 v[156:159], v16 offset:24384
    v_exp_f32 v62, v62
    v_exp_f32 v63, v63
    v_exp_f32 v96, v96
    v_exp_f32 v97, v97
    v_smfmac_f32_32x32x32_bf16 v[64:79], v[160:163], v[56:63], v19
    ds_read_b128 v[160:163], v16 offset:25056
    v_exp_f32 v98, v98
    v_exp_f32 v99, v99
    v_exp_f32 v100, v100
    v_exp_f32 v101, v101
    s_waitcnt lgkmcnt(1)
    v_mfma_f32_32x32x16_bf16 v[32:47], v[152:155], v[144:147], 0
    v_exp_f32 v102, v102
    v_exp_f32 v103, v103
    v_exp_f32 v104, v104
    v_exp_f32 v105, v105
    v_mfma_f32_32x32x8_bf16 v[32:47], v[150:151], v[148:149], v[32:47]
    v_exp_f32 v106, v106
    v_exp_f32 v107, v107
    v_exp_f32 v108, v108
    v_exp_f32 v109, v109
    v_smfmac_f32_32x32x32_bf16 v[128:143], v[156:159], v[96:103], v19
    v_exp_f32 v110, v110
    v_exp_f32 v111, v111
    v_exp_f32 v112, v112
    v_exp_f32 v113, v113
    s_waitcnt lgkmcnt(0)
    v_smfmac_f32_32x32x32_bf16 v[128:143], v[160:163], v[104:111], v19
    s_waitcnt vmcnt(2)
    ds_write_b32 v20, v22
    v_exp_f32 v114, v114
    v_exp_f32 v115, v115
    v_exp_f32 v116, v116
    v_exp_f32 v117, v117
    v_mfma_f32_32x32x16_bf16 v[48:63], v[152:155], v[8:11], 0
    ds_read_b128 v[152:155], v14 offset:36096
    v_exp_f32 v118, v118
    v_exp_f32 v119, v119
    v_exp_f32 v120, v120
    v_exp_f32 v121, v121
    v_mfma_f32_32x32x8_bf16 v[48:63], v[150:151], v[12:13], v[48:63]
    ds_read_b64 v[150:151], v15 offset:36096
    v_add_u32 v22, 1, v22
    v_exp_f32 v122, v122
    v_exp_f32 v123, v123
    v_exp_f32 v124, v124
    v_exp_f32 v125, v125
    v_smfmac_f32_32x32x32_bf16 v[64:79], v[156:159], v[112:119], v19
    ds_read_b128 v[156:159], v16 offset:34560
    v_exp_f32 v126, v126
    v_exp_f32 v127, v127
    v_exp_f32 v32, v32
    v_exp_f32 v33, v33
    v_smfmac_f32_32x32x32_bf16 v[64:79], v[160:163], v[120:127], v19
    ds_read_b128 v[160:163], v16 offset:35232
    s_cmp_eq_u32 s69, 1
    s_cselect_b32 s52, 25165824, s52
    s_cselect_b32 s53, 25165824, s53
    s_cselect_b32 s54, 0x30000, s54
    s_cselect_b32 s55, 0x30000, s55
    v_exp_f32 v34, v34
    v_exp_f32 v35, v35
    v_exp_f32 v36, v36
    v_exp_f32 v37, v37
    s_waitcnt lgkmcnt(1)
    v_mfma_f32_32x32x16_bf16 v[96:111], v[152:155], v[144:147], 0
    v_exp_f32 v38, v38
    v_exp_f32 v39, v39
    v_exp_f32 v40, v40
    v_exp_f32 v41, v41
    v_mfma_f32_32x32x8_bf16 v[96:111], v[150:151], v[148:149], v[96:111]
    ds_read_b32 v30, v21
    v_exp_f32 v42, v42
    v_exp_f32 v43, v43
    v_exp_f32 v44, v44
    v_exp_f32 v45, v45
    v_smfmac_f32_32x32x32_bf16 v[128:143], v[156:159], v[32:39], v19
    v_exp_f32 v46, v46
    v_exp_f32 v47, v47
    v_exp_f32 v48, v48
    v_exp_f32 v49, v49
    s_waitcnt lgkmcnt(0)
    v_smfmac_f32_32x32x32_bf16 v[128:143], v[160:163], v[40:47], v19
    v_cmp_gt_u32 vcc, s3, v30
    s_cbranch_vccnz gated_mix__mha_block__mixer_token_mlp__prompt_kernel_ool53
gated_mix__mha_block__mixer_token_mlp__prompt_kernel_back54:
    v_exp_f32 v50, v50
    v_exp_f32 v51, v51
    v_exp_f32 v52, v52
    v_exp_f32 v53, v53
    v_mfma_f32_32x32x16_bf16 v[112:127], v[152:155], v[8:11], 0
    ds_read_b128 v[152:155], v14 offset:0
    v_exp_f32 v54, v54
    v_exp_f32 v55, v55
    v_exp_f32 v56, v56
    v_exp_f32 v57, v57
    v_mfma_f32_32x32x8_bf16 v[112:127], v[150:151], v[12:13], v[112:127]
    ds_read_b64 v[150:151], v15 offset:0
    s_add_u32 m0, s54, 23040
    s_mov_b64 exec, s[58:59]
    buffer_load_dwordx4 v17, s[24:27], s52 offen sc1 lds
    s_add_u32 m0, s55, 23040
    s_mov_b64 exec, s[60:61]
    buffer_load_dwordx4 v18, s[24:27], s53 offen sc1 lds
    s_mov_b64 exec, -1
    s_add_u32 s52, s52, 2048
    s_add_u32 s53, s53, 5120
    s_add_u32 s3, s3, 1
    v_exp_f32 v58, v58
    v_exp_f32 v59, v59
    v_exp_f32 v60, v60
    v_exp_f32 v61, v61
    v_smfmac_f32_32x32x32_bf16 v[64:79], v[156:159], v[48:55], v19
    ds_read_b128 v[156:159], v16 offset:35904
    v_exp_f32 v62, v62
    v_exp_f32 v63, v63
    v_exp_f32 v96, v96
    v_exp_f32 v97, v97
    v_smfmac_f32_32x32x32_bf16 v[64:79], v[160:163], v[56:63], v19
    ds_read_b128 v[160:163], v16 offset:36576
    v_exp_f32 v98, v98
    v_exp_f32 v99, v99
    v_exp_f32 v100, v100
    v_exp_f32 v101, v101
    s_waitcnt lgkmcnt(1)
    v_mfma_f32_32x32x16_bf16 v[32:47], v[152:155], v[144:147], 0
    v_exp_f32 v102, v102
    v_exp_f32 v103, v103
    v_exp_f32 v104, v104
    v_exp_f32 v105, v105
    v_mfma_f32_32x32x8_bf16 v[32:47], v[150:151], v[148:149], v[32:47]
    v_exp_f32 v106, v106
    v_exp_f32 v107, v107
    v_exp_f32 v108, v108
    v_exp_f32 v109, v109
    v_smfmac_f32_32x32x32_bf16 v[128:143], v[156:159], v[96:103], v19
    v_exp_f32 v110, v110
    v_exp_f32 v111, v111
    v_exp_f32 v112, v112
    v_exp_f32 v113, v113
    s_waitcnt lgkmcnt(0)
    v_smfmac_f32_32x32x32_bf16 v[128:143], v[160:163], v[104:111], v19
    s_waitcnt vmcnt(2)
    ds_write_b32 v20, v22
    v_exp_f32 v114, v114
    v_exp_f32 v115, v115
    v_exp_f32 v116, v116
    v_exp_f32 v117, v117
    v_mfma_f32_32x32x16_bf16 v[48:63], v[152:155], v[8:11], 0
    ds_read_b128 v[152:155], v14 offset:1536
    v_exp_f32 v118, v118
    v_exp_f32 v119, v119
    v_exp_f32 v120, v120
    v_exp_f32 v121, v121
    v_mfma_f32_32x32x8_bf16 v[48:63], v[150:151], v[12:13], v[48:63]
    ds_read_b64 v[150:151], v15 offset:1536
    v_add_u32 v22, 1, v22
    v_exp_f32 v122, v122
    v_exp_f32 v123, v123
    v_exp_f32 v124, v124
    v_exp_f32 v125, v125
    v_smfmac_f32_32x32x32_bf16 v[64:79], v[156:159], v[112:119], v19
    ds_read_b128 v[156:159], v16 offset:0
    v_exp_f32 v126, v126
    v_exp_f32 v127, v127
    v_exp_f32 v32, v32
    v_exp_f32 v33, v33
    v_smfmac_f32_32x32x32_bf16 v[64:79], v[160:163], v[120:127], v19
    ds_read_b128 v[160:163], v16 offset:672
    v_exp_f32 v34, v34
    v_exp_f32 v35, v35
    v_exp_f32 v36, v36
    v_exp_f32 v37, v37
    s_waitcnt lgkmcnt(1)
    v_mfma_f32_32x32x16_bf16 v[96:111], v[152:155], v[144:147], 0
    v_exp_f32 v38, v38
    v_exp_f32 v39, v39
    v_exp_f32 v40, v40
    v_exp_f32 v41, v41
    v_mfma_f32_32x32x8_bf16 v[96:111], v[150:151], v[148:149], v[96:111]
    ds_read_b32 v30, v21
    v_exp_f32 v42, v42
    v_exp_f32 v43, v43
    v_exp_f32 v44, v44
    v_exp_f32 v45, v45
    v_smfmac_f32_32x32x32_bf16 v[128:143], v[156:159], v[32:39], v19
    v_exp_f32 v46, v46
    v_exp_f32 v47, v47
    v_exp_f32 v48, v48
    v_exp_f32 v49, v49
    s_waitcnt lgkmcnt(0)
    v_smfmac_f32_32x32x32_bf16 v[128:143], v[160:163], v[40:47], v19
    v_cmp_gt_u32 vcc, s3, v30
    s_cbranch_vccnz gated_mix__mha_block__mixer_token_mlp__prompt_kernel_ool57
gated_mix__mha_block__mixer_token_mlp__prompt_kernel_back58:
    v_exp_f32 v50, v50
    v_exp_f32 v51, v51
    v_exp_f32 v52, v52
    v_exp_f32 v53, v53
    v_mfma_f32_32x32x16_bf16 v[112:127], v[152:155], v[8:11], 0
    ds_read_b128 v[152:155], v14 offset:11520
    v_exp_f32 v54, v54
    v_exp_f32 v55, v55
    v_exp_f32 v56, v56
    v_exp_f32 v57, v57
    v_mfma_f32_32x32x8_bf16 v[112:127], v[150:151], v[12:13], v[112:127]
    ds_read_b64 v[150:151], v15 offset:11520
    s_add_u32 m0, s54, 34560
    s_mov_b64 exec, s[58:59]
    buffer_load_dwordx4 v17, s[24:27], s52 offen sc1 lds
    s_add_u32 m0, s55, 34560
    s_mov_b64 exec, s[60:61]
    buffer_load_dwordx4 v18, s[24:27], s53 offen sc1 lds
    s_mov_b64 exec, -1
    s_add_u32 s52, s52, 2048
    s_add_u32 s53, s53, 5120
    s_add_u32 s3, s3, 1
    v_exp_f32 v58, v58
    v_exp_f32 v59, v59
    v_exp_f32 v60, v60
    v_exp_f32 v61, v61
    v_smfmac_f32_32x32x32_bf16 v[64:79], v[156:159], v[48:55], v19
    ds_read_b128 v[156:159], v16 offset:1344
    v_exp_f32 v62, v62
    v_exp_f32 v63, v63
    v_exp_f32 v96, v96
    v_exp_f32 v97, v97
    v_smfmac_f32_32x32x32_bf16 v[64:79], v[160:163], v[56:63], v19
    ds_read_b128 v[160:163], v16 offset:2016
    v_exp_f32 v98, v98
    v_exp_f32 v99, v99
    v_exp_f32 v100, v100
    v_exp_f32 v101, v101
    s_waitcnt lgkmcnt(1)
    v_mfma_f32_32x32x16_bf16 v[32:47], v[152:155], v[144:147], 0
    v_exp_f32 v102, v102
    v_exp_f32 v103, v103
    v_exp_f32 v104, v104
    v_exp_f32 v105, v105
    v_mfma_f32_32x32x8_bf16 v[32:47], v[150:151], v[148:149], v[32:47]
    v_exp_f32 v106, v106
    v_exp_f32 v107, v107
    v_exp_f32 v108, v108
    v_exp_f32 v109, v109
    v_smfmac_f32_32x32x32_bf16 v[128:143], v[156:159], v[96:103], v19
    v_exp_f32 v110, v110
    v_exp_f32 v111, v111
    v_exp_f32 v112, v112
    v_exp_f32 v113, v113
    s_waitcnt lgkmcnt(0)
    v_smfmac_f32_32x32x32_bf16 v[128:143], v[160:163], v[104:111], v19
    s_waitcnt vmcnt(2)
    ds_write_b32 v20, v22
    v_exp_f32 v114, v114
    v_exp_f32 v115, v115
    v_exp_f32 v116, v116
    v_exp_f32 v117, v117
    v_mfma_f32_32x32x16_bf16 v[48:63], v[152:155], v[8:11], 0
    ds_read_b128 v[152:155], v14 offset:13056
    v_exp_f32 v118, v118
    v_exp_f32 v119, v119
    v_exp_f32 v120, v120
    v_exp_f32 v121, v121
    v_mfma_f32_32x32x8_bf16 v[48:63], v[150:151], v[12:13], v[48:63]
    ds_read_b64 v[150:151], v15 offset:13056
    v_add_u32 v22, 1, v22
    v_exp_f32 v122, v122
    v_exp_f32 v123, v123
    v_exp_f32 v124, v124
    v_exp_f32 v125, v125
    v_smfmac_f32_32x32x32_bf16 v[64:79], v[156:159], v[112:119], v19
    ds_read_b128 v[156:159], v16 offset:11520
    v_exp_f32 v126, v126
    v_exp_f32 v127, v127
    v_exp_f32 v32, v32
    v_exp_f32 v33, v33
    v_smfmac_f32_32x32x32_bf16 v[64:79], v[160:163], v[120:127], v19
    ds_read_b128 v[160:163], v16 offset:12192
    v_exp_f32 v34, v34
    v_exp_f32 v35, v35
    v_exp_f32 v36, v36
    v_exp_f32 v37, v37
    s_waitcnt lgkmcnt(1)
    v_mfma_f32_32x32x16_bf16 v[96:111], v[152:155], v[144:147], 0
    v_exp_f32 v38, v38
    v_exp_f32 v39, v39
    v_exp_f32 v40, v40
    v_exp_f32 v41, v41
    v_mfma_f32_32x32x8_bf16 v[96:111], v[150:151], v[148:149], v[96:111]
    ds_read_b32 v30, v21
    v_exp_f32 v42, v42
    v_exp_f32 v43, v43
    v_exp_f32 v44, v44
    v_exp_f32 v45, v45
    v_smfmac_f32_32x32x32_bf16 v[128:143], v[156:159], v[32:39], v19
    v_exp_f32 v46, v46
    v_exp_f32 v47, v47
    v_exp_f32 v48, v48
    v_exp_f32 v49, v49
    s_waitcnt lgkmcnt(0)
    v_smfmac_f32_32x32x32_bf16 v[128:143], v[160:163], v[40:47], v19
    v_cmp_gt_u32 vcc, s3, v30
    s_cbranch_vccnz gated_mix__mha_block__mixer_token_mlp__prompt_kernel_ool61
gated_mix__mha_block__mixer_token_mlp__prompt_kernel_back62:
    v_exp_f32 v50, v50
    v_exp_f32 v51, v51
    v_exp_f32 v52, v52
    v_exp_f32 v53, v53
    v_mfma_f32_32x32x16_bf16 v[112:127], v[152:155], v[8:11], 0
    ds_read_b128 v[152:155], v14 offset:23040
    v_exp_f32 v54, v54
    v_exp_f32 v55, v55
    v_exp_f32 v56, v56
    v_exp_f32 v57, v57
    v_mfma_f32_32x32x8_bf16 v[112:127], v[150:151], v[12:13], v[112:127]
    ds_read_b64 v[150:151], v15 offset:23040
    s_add_u32 m0, s54, 0
    s_mov_b64 exec, s[58:59]
    buffer_load_dwordx4 v17, s[24:27], s52 offen sc1 lds
    s_add_u32 m0, s55, 0
    s_mov_b64 exec, s[60:61]
    buffer_load_dwordx4 v18, s[24:27], s53 offen sc1 lds
    s_mov_b64 exec, -1
    s_add_u32 s52, s52, 2048
    s_add_u32 s53, s53, 5120
    s_add_u32 s3, s3, 1
    v_exp_f32 v58, v58
    v_exp_f32 v59, v59
    v_exp_f32 v60, v60
    v_exp_f32 v61, v61
    v_smfmac_f32_32x32x32_bf16 v[64:79], v[156:159], v[48:55], v19
    ds_read_b128 v[156:159], v16 offset:12864
    v_exp_f32 v62, v62
    v_exp_f32 v63, v63
    s_sub_u32 s69, s69, 1
    s_cmp_eq_u32 s69, 0
    s_cbranch_scc1 gated_mix__mha_block__mixer_token_mlp__prompt_kernel_join47
    v_exp_f32 v96, v96
    v_exp_f32 v97, v97
    v_smfmac_f32_32x32x32_bf16 v[64:79], v[160:163], v[56:63], v19
    ds_read_b128 v[160:163], v16 offset:13536
    v_exp_f32 v98, v98
    v_exp_f32 v99, v99
    v_exp_f32 v100, v100
    v_exp_f32 v101, v101
    s_waitcnt lgkmcnt(1)
    v_mfma_f32_32x32x16_bf16 v[32:47], v[152:155], v[144:147], 0
    v_exp_f32 v102, v102
    v_exp_f32 v103, v103
    v_exp_f32 v104, v104
    v_exp_f32 v105, v105
    v_mfma_f32_32x32x8_bf16 v[32:47], v[150:151], v[148:149], v[32:47]
    v_exp_f32 v106, v106
    v_exp_f32 v107, v107
    v_exp_f32 v108, v108
    v_exp_f32 v109, v109
    v_smfmac_f32_32x32x32_bf16 v[128:143], v[156:159], v[96:103], v19
    v_exp_f32 v110, v110
    v_exp_f32 v111, v111
    v_exp_f32 v112, v112
    v_exp_f32 v113, v113
    s_waitcnt lgkmcnt(0)
    v_smfmac_f32_32x32x32_bf16 v[128:143], v[160:163], v[104:111], v19
    s_waitcnt vmcnt(2)
    ds_write_b32 v20, v22
    v_exp_f32 v114, v114
    v_exp_f32 v115, v115
    v_exp_f32 v116, v116
    v_exp_f32 v117, v117
    v_mfma_f32_32x32x16_bf16 v[48:63], v[152:155], v[8:11], 0
    ds_read_b128 v[152:155], v14 offset:24576
    v_exp_f32 v118, v118
    v_exp_f32 v119, v119
    v_exp_f32 v120, v120
    v_exp_f32 v121, v121
    v_mfma_f32_32x32x8_bf16 v[48:63], v[150:151], v[12:13], v[48:63]
    ds_read_b64 v[150:151], v15 offset:24576
    v_add_u32 v22, 1, v22
    v_exp_f32 v122, v122
    v_exp_f32 v123, v123
    v_exp_f32 v124, v124
    v_exp_f32 v125, v125
    v_smfmac_f32_32x32x32_bf16 v[64:79], v[156:159], v[112:119], v19
    ds_read_b128 v[156:159], v16 offset:23040
    v_exp_f32 v126, v126
    v_exp_f32 v127, v127
    s_branch gated_mix__mha_block__mixer_token_mlp__prompt_kernel_attl48
gated_mix__mha_block__mixer_token_mlp__prompt_kernel_young46:
    s_setprio 1
.p2align 6
gated_mix__mha_block__mixer_token_mlp__prompt_kernel_attl65:
    s_setprio 2
    v_exp_f32 v32, v32
    v_exp_f32 v33, v33
    v_smfmac_f32_32x32x32_bf16 v[64:79], v[160:163], v[120:127], v19
    ds_read_b128 v[160:163], v16 offset:23712
    v_exp_f32 v34, v34
    v_exp_f32 v35, v35
    v_exp_f32 v36, v36
    v_exp_f32 v37, v37
    s_waitcnt lgkmcnt(1)
    v_mfma_f32_32x32x16_bf16 v[96:111], v[152:155], v[144:147], 0
    v_exp_f32 v38, v38
    v_exp_f32 v39, v39
    v_exp_f32 v40, v40
    v_exp_f32 v41, v41
    v_mfma_f32_32x32x8_bf16 v[96:111], v[150:151], v[148:149], v[96:111]
    ds_read_b32 v30, v21
    v_exp_f32 v42, v42
    v_exp_f32 v43, v43
    v_exp_f32 v44, v44
    v_exp_f32 v45, v45
    v_smfmac_f32_32x32x32_bf16 v[128:143], v[156:159], v[32:39], v19
    v_exp_f32 v46, v46
    v_exp_f32 v47, v47
    v_exp_f32 v48, v48
    v_exp_f32 v49, v49
    s_waitcnt lgkmcnt(0)
    v_smfmac_f32_32x32x32_bf16 v[128:143], v[160:163], v[40:47], v19
    v_cmp_gt_u32 vcc, s3, v30
    s_cbranch_vccnz gated_mix__mha_block__mixer_token_mlp__prompt_kernel_ool66
gated_mix__mha_block__mixer_token_mlp__prompt_kernel_back67:
    v_exp_f32 v50, v50
    v_exp_f32 v51, v51
    v_exp_f32 v52, v52
    v_exp_f32 v53, v53
    v_mfma_f32_32x32x16_bf16 v[112:127], v[152:155], v[8:11], 0
    ds_read_b128 v[152:155], v14 offset:34560
    v_exp_f32 v54, v54
    v_exp_f32 v55, v55
    v_exp_f32 v56, v56
    v_exp_f32 v57, v57
    v_mfma_f32_32x32x8_bf16 v[112:127], v[150:151], v[12:13], v[112:127]
    ds_read_b64 v[150:151], v15 offset:34560
    s_add_u32 s3, s3, 1
    v_exp_f32 v58, v58
    v_exp_f32 v59, v59
    v_exp_f32 v60, v60
    v_exp_f32 v61, v61
    v_smfmac_f32_32x32x32_bf16 v[64:79], v[156:159], v[48:55], v19
    ds_read_b128 v[156:159], v16 offset:24384
    v_exp_f32 v62, v62
    v_exp_f32 v63, v63
    v_exp_f32 v96, v96
    v_exp_f32 v97, v97
    v_smfmac_f32_32x32x32_bf16 v[64:79], v[160:163], v[56:63], v19
    ds_read_b128 v[160:163], v16 offset:25056
    v_exp_f32 v98, v98
    v_exp_f32 v99, v99
    v_exp_f32 v100, v100
    v_exp_f32 v101, v101
    s_waitcnt lgkmcnt(1)
    v_mfma_f32_32x32x16_bf16 v[32:47], v[152:155], v[144:147], 0
    v_exp_f32 v102, v102
    v_exp_f32 v103, v103
    v_exp_f32 v104, v104
    v_exp_f32 v105, v105
    v_mfma_f32_32x32x8_bf16 v[32:47], v[150:151], v[148:149], v[32:47]
    v_exp_f32 v106, v106
    v_exp_f32 v107, v107
    v_exp_f32 v108, v108
    v_exp_f32 v109, v109
    v_smfmac_f32_32x32x32_bf16 v[128:143], v[156:159], v[96:103], v19
    v_exp_f32 v110, v110
    v_exp_f32 v111, v111
    s_setprio 1
    v_exp_f32 v112, v112
    v_exp_f32 v113, v113
    s_waitcnt lgkmcnt(0)
    v_smfmac_f32_32x32x32_bf16 v[128:143], v[160:163], v[104:111], v19
    s_add_u32 m0, s54, 11520
    s_mov_b64 exec, s[58:59]
    buffer_load_dwordx4 v17, s[24:27], s52 offen sc1 lds
    s_add_u32 m0, s55, 11520
    s_mov_b64 exec, s[60:61]
    buffer_load_dwordx4 v18, s[24:27], s53 offen sc1 lds
    s_mov_b64 exec, -1
    s_add_u32 s52, s52, 2048
    s_add_u32 s53, s53, 5120
    s_waitcnt vmcnt(2)
    ds_write_b32 v20, v22
    v_exp_f32 v114, v114
    v_exp_f32 v115, v115
    v_exp_f32 v116, v116
    v_exp_f32 v117, v117
    v_mfma_f32_32x32x16_bf16 v[48:63], v[152:155], v[8:11], 0
    ds_read_b128 v[152:155], v14 offset:36096
    v_exp_f32 v118, v118
    v_exp_f32 v119, v119
    v_exp_f32 v120, v120
    v_exp_f32 v121, v121
    v_mfma_f32_32x32x8_bf16 v[48:63], v[150:151], v[12:13], v[48:63]
    ds_read_b64 v[150:151], v15 offset:36096
    v_add_u32 v22, 1, v22
    v_exp_f32 v122, v122
    v_exp_f32 v123, v123
    v_exp_f32 v124, v124
    v_exp_f32 v125, v125
    v_smfmac_f32_32x32x32_bf16 v[64:79], v[156:159], v[112:119], v19
    ds_read_b128 v[156:159], v16 offset:34560
    v_exp_f32 v126, v126
    v_exp_f32 v127, v127
    s_setprio 2
    v_exp_f32 v32, v32
    v_exp_f32 v33, v33
    v_smfmac_f32_32x32x32_bf16 v[64:79], v[160:163], v[120:127], v19
    ds_read_b128 v[160:163], v16 offset:35232
    s_cmp_eq_u32 s69, 1
    s_cselect_b32 s52, 25165824, s52
    s_cselect_b32 s53, 25165824, s53
    s_cselect_b32 s54, 0x30000, s54
    s_cselect_b32 s55, 0x30000, s55
    v_exp_f32 v34, v34
    v_exp_f32 v35, v35
    v_exp_f32 v36, v36
    v_exp_f32 v37, v37
    s_waitcnt lgkmcnt(1)
    v_mfma_f32_32x32x16_bf16 v[96:111], v[152:155], v[144:147], 0
    v_exp_f32 v38, v38
    v_exp_f32 v39, v39
    v_exp_f32 v40, v40
    v_exp_f32 v41, v41
    v_mfma_f32_32x32x8_bf16 v[96:111], v[150:151], v[148:149], v[96:111]
    ds_read_b32 v30, v21
    v_exp_f32 v42, v42
    v_exp_f32 v43, v43
    v_exp_f32 v44, v44
    v_exp_f32 v45, v45
    v_smfmac_f32_32x32x32_bf16 v[128:143], v[156:159], v[32:39], v19
    v_exp_f32 v46, v46
    v_exp_f32 v47, v47
    v_exp_f32 v48, v48
    v_exp_f32 v49, v49
    s_waitcnt lgkmcnt(0)
    v_smfmac_f32_32x32x32_bf16 v[128:143], v[160:163], v[40:47], v19
    v_cmp_gt_u32 vcc, s3, v30
    s_cbranch_vccnz gated_mix__mha_block__mixer_token_mlp__prompt_kernel_ool70
gated_mix__mha_block__mixer_token_mlp__prompt_kernel_back71:
    v_exp_f32 v50, v50
    v_exp_f32 v51, v51
    v_exp_f32 v52, v52
    v_exp_f32 v53, v53
    v_mfma_f32_32x32x16_bf16 v[112:127], v[152:155], v[8:11], 0
    ds_read_b128 v[152:155], v14 offset:0
    v_exp_f32 v54, v54
    v_exp_f32 v55, v55
    v_exp_f32 v56, v56
    v_exp_f32 v57, v57
    v_mfma_f32_32x32x8_bf16 v[112:127], v[150:151], v[12:13], v[112:127]
    ds_read_b64 v[150:151], v15 offset:0
    s_add_u32 s3, s3, 1
    v_exp_f32 v58, v58
    v_exp_f32 v59, v59
    v_exp_f32 v60, v60
    v_exp_f32 v61, v61
    v_smfmac_f32_32x32x32_bf16 v[64:79], v[156:159], v[48:55], v19
    ds_read_b128 v[156:159], v16 offset:35904
    v_exp_f32 v62, v62
    v_exp_f32 v63, v63
    v_exp_f32 v96, v96
    v_exp_f32 v97, v97
    v_smfmac_f32_32x32x32_bf16 v[64:79], v[160:163], v[56:63], v19
    ds_read_b128 v[160:163], v16 offset:36576
    v_exp_f32 v98, v98
    v_exp_f32 v99, v99
    v_exp_f32 v100, v100
    v_exp_f32 v101, v101
    s_waitcnt lgkmcnt(1)
    v_mfma_f32_32x32x16_bf16 v[32:47], v[152:155], v[144:147], 0
    v_exp_f32 v102, v102
    v_exp_f32 v103, v103
    v_exp_f32 v104, v104
    v_exp_f32 v105, v105
    v_mfma_f32_32x32x8_bf16 v[32:47], v[150:151], v[148:149], v[32:47]
    v_exp_f32 v106, v106
    v_exp_f32 v107, v107
    v_exp_f32 v108, v108
    v_exp_f32 v109, v109
    v_smfmac_f32_32x32x32_bf16 v[128:143], v[156:159], v[96:103], v19
    v_exp_f32 v110, v110
    v_exp_f32 v111, v111
    s_setprio 1
    v_exp_f32 v112, v112
    v_exp_f32 v113, v113
    s_waitcnt lgkmcnt(0)
    v_smfmac_f32_32x32x32_bf16 v[128:143], v[160:163], v[104:111], v19
    s_add_u32 m0, s54, 23040
    s_mov_b64 exec, s[58:59]
    buffer_load_dwordx4 v17, s[24:27], s52 offen sc1 lds
    s_add_u32 m0, s55, 23040
    s_mov_b64 exec, s[60:61]
    buffer_load_dwordx4 v18, s[24:27], s53 offen sc1 lds
    s_mov_b64 exec, -1
    s_add_u32 s52, s52, 2048
    s_add_u32 s53, s53, 5120
    s_waitcnt vmcnt(2)
    ds_write_b32 v20, v22
    v_exp_f32 v114, v114
    v_exp_f32 v115, v115
    v_exp_f32 v116, v116
    v_exp_f32 v117, v117
    v_mfma_f32_32x32x16_bf16 v[48:63], v[152:155], v[8:11], 0
    ds_read_b128 v[152:155], v14 offset:1536
    v_exp_f32 v118, v118
    v_exp_f32 v119, v119
    v_exp_f32 v120, v120
    v_exp_f32 v121, v121
    v_mfma_f32_32x32x8_bf16 v[48:63], v[150:151], v[12:13], v[48:63]
    ds_read_b64 v[150:151], v15 offset:1536
    v_add_u32 v22, 1, v22
    v_exp_f32 v122, v122
    v_exp_f32 v123, v123
    v_exp_f32 v124, v124
    v_exp_f32 v125, v125
    v_smfmac_f32_32x32x32_bf16 v[64:79], v[156:159], v[112:119], v19
    ds_read_b128 v[156:159], v16 offset:0
    v_exp_f32 v126, v126
    v_exp_f32 v127, v127
    s_setprio 2
    v_exp_f32 v32, v32
    v_exp_f32 v33, v33
    v_smfmac_f32_32x32x32_bf16 v[64:79], v[160:163], v[120:127], v19
    ds_read_b128 v[160:163], v16 offset:672
    v_exp_f32 v34, v34
    v_exp_f32 v35, v35
    v_exp_f32 v36, v36
    v_exp_f32 v37, v37
    s_waitcnt lgkmcnt(1)
    v_mfma_f32_32x32x16_bf16 v[96:111], v[152:155], v[144:147], 0
    v_exp_f32 v38, v38
    v_exp_f32 v39, v39
    v_exp_f32 v40, v40
    v_exp_f32 v41, v41
    v_mfma_f32_32x32x8_bf16 v[96:111], v[150:151], v[148:149], v[96:111]
    ds_read_b32 v30, v21
    v_exp_f32 v42, v42
    v_exp_f32 v43, v43
    v_exp_f32 v44, v44
    v_exp_f32 v45, v45
    v_smfmac_f32_32x32x32_bf16 v[128:143], v[156:159], v[32:39], v19
    v_exp_f32 v46, v46
    v_exp_f32 v47, v47
    v_exp_f32 v48, v48
    v_exp_f32 v49, v49
    s_waitcnt lgkmcnt(0)
    v_smfmac_f32_32x32x32_bf16 v[128:143], v[160:163], v[40:47], v19
    v_cmp_gt_u32 vcc, s3, v30
    s_cbranch_vccnz gated_mix__mha_block__mixer_token_mlp__prompt_kernel_ool74
gated_mix__mha_block__mixer_token_mlp__prompt_kernel_back75:
    v_exp_f32 v50, v50
    v_exp_f32 v51, v51
    v_exp_f32 v52, v52
    v_exp_f32 v53, v53
    v_mfma_f32_32x32x16_bf16 v[112:127], v[152:155], v[8:11], 0
    ds_read_b128 v[152:155], v14 offset:11520
    v_exp_f32 v54, v54
    v_exp_f32 v55, v55
    v_exp_f32 v56, v56
    v_exp_f32 v57, v57
    v_mfma_f32_32x32x8_bf16 v[112:127], v[150:151], v[12:13], v[112:127]
    ds_read_b64 v[150:151], v15 offset:11520
    s_add_u32 s3, s3, 1
    v_exp_f32 v58, v58
    v_exp_f32 v59, v59
    v_exp_f32 v60, v60
    v_exp_f32 v61, v61
    v_smfmac_f32_32x32x32_bf16 v[64:79], v[156:159], v[48:55], v19
    ds_read_b128 v[156:159], v16 offset:1344
    v_exp_f32 v62, v62
    v_exp_f32 v63, v63
    v_exp_f32 v96, v96
    v_exp_f32 v97, v97
    v_smfmac_f32_32x32x32_bf16 v[64:79], v[160:163], v[56:63], v19
    ds_read_b128 v[160:163], v16 offset:2016
    v_exp_f32 v98, v98
    v_exp_f32 v99, v99
    v_exp_f32 v100, v100
    v_exp_f32 v101, v101
    s_waitcnt lgkmcnt(1)
    v_mfma_f32_32x32x16_bf16 v[32:47], v[152:155], v[144:147], 0
    v_exp_f32 v102, v102
    v_exp_f32 v103, v103
    v_exp_f32 v104, v104
    v_exp_f32 v105, v105
    v_mfma_f32_32x32x8_bf16 v[32:47], v[150:151], v[148:149], v[32:47]
    v_exp_f32 v106, v106
    v_exp_f32 v107, v107
    v_exp_f32 v108, v108
    v_exp_f32 v109, v109
    v_smfmac_f32_32x32x32_bf16 v[128:143], v[156:159], v[96:103], v19
    v_exp_f32 v110, v110
    v_exp_f32 v111, v111
    s_setprio 1
    v_exp_f32 v112, v112
    v_exp_f32 v113, v113
    s_waitcnt lgkmcnt(0)
    v_smfmac_f32_32x32x32_bf16 v[128:143], v[160:163], v[104:111], v19
    s_add_u32 m0, s54, 34560
    s_mov_b64 exec, s[58:59]
    buffer_load_dwordx4 v17, s[24:27], s52 offen sc1 lds
    s_add_u32 m0, s55, 34560
    s_mov_b64 exec, s[60:61]
    buffer_load_dwordx4 v18, s[24:27], s53 offen sc1 lds
    s_mov_b64 exec, -1
    s_add_u32 s52, s52, 2048
    s_add_u32 s53, s53, 5120
    s_waitcnt vmcnt(2)
    ds_write_b32 v20, v22
    v_exp_f32 v114, v114
    v_exp_f32 v115, v115
    v_exp_f32 v116, v116
    v_exp_f32 v117, v117
    v_mfma_f32_32x32x16_bf16 v[48:63], v[152:155], v[8:11], 0
    ds_read_b128 v[152:155], v14 offset:13056
    v_exp_f32 v118, v118
    v_exp_f32 v119, v119
    v_exp_f32 v120, v120
    v_exp_f32 v121, v121
    v_mfma_f32_32x32x8_bf16 v[48:63], v[150:151], v[12:13], v[48:63]
    ds_read_b64 v[150:151], v15 offset:13056
    v_add_u32 v22, 1, v22
    v_exp_f32 v122, v122
    v_exp_f32 v123, v123
    v_exp_f32 v124, v124
    v_exp_f32 v125, v125
    v_smfmac_f32_32x32x32_bf16 v[64:79], v[156:159], v[112:119], v19
    ds_read_b128 v[156:159], v16 offset:11520
    v_exp_f32 v126, v126
    v_exp_f32 v127, v127
    s_setprio 2
    v_exp_f32 v32, v32
    v_exp_f32 v33, v33
    v_smfmac_f32_32x32x32_bf16 v[64:79], v[160:163], v[120:127], v19
    ds_read_b128 v[160:163], v16 offset:12192
    v_exp_f32 v34, v34
    v_exp_f32 v35, v35
    v_exp_f32 v36, v36
    v_exp_f32 v37, v37
    s_waitcnt lgkmcnt(1)
    v_mfma_f32_32x32x16_bf16 v[96:111], v[152:155], v[144:147], 0
    v_exp_f32 v38, v38
    v_exp_f32 v39, v39
    v_exp_f32 v40, v40
    v_exp_f32 v41, v41
    v_mfma_f32_32x32x8_bf16 v[96:111], v[150:151], v[148:149], v[96:111]
    ds_read_b32 v30, v21
    v_exp_f32 v42, v42
    v_exp_f32 v43, v43
    v_exp_f32 v44, v44
    v_exp_f32 v45, v45
    v_smfmac_f32_32x32x32_bf16 v[128:143], v[156:159], v[32:39], v19
    v_exp_f32 v46, v46
    v_exp_f32 v47, v47
    v_exp_f32 v48, v48
    v_exp_f32 v49, v49
    s_waitcnt lgkmcnt(0)
    v_smfmac_f32_32x32x32_bf16 v[128:143], v[160:163], v[40:47], v19
    v_cmp_gt_u32 vcc, s3, v30
    s_cbranch_vccnz gated_mix__mha_block__mixer_token_mlp__prompt_kernel_ool78
gated_mix__mha_block__mixer_token_mlp__prompt_kernel_back79:
    v_exp_f32 v50, v50
    v_exp_f32 v51, v51
    v_exp_f32 v52, v52
    v_exp_f32 v53, v53
    v_mfma_f32_32x32x16_bf16 v[112:127], v[152:155], v[8:11], 0
    ds_read_b128 v[152:155], v14 offset:23040
    v_exp_f32 v54, v54
    v_exp_f32 v55, v55
    v_exp_f32 v56, v56
    v_exp_f32 v57, v57
    v_mfma_f32_32x32x8_bf16 v[112:127], v[150:151], v[12:13], v[112:127]
    ds_read_b64 v[150:151], v15 offset:23040
    s_add_u32 s3, s3, 1
    v_exp_f32 v58, v58
    v_exp_f32 v59, v59
    v_exp_f32 v60, v60
    v_exp_f32 v61, v61
    v_smfmac_f32_32x32x32_bf16 v[64:79], v[156:159], v[48:55], v19
    ds_read_b128 v[156:159], v16 offset:12864
    v_exp_f32 v62, v62
    v_exp_f32 v63, v63
    s_sub_u32 s69, s69, 1
    s_cmp_eq_u32 s69, 0
    s_cbranch_scc1 gated_mix__mha_block__mixer_token_mlp__prompt_kernel_join47
    v_exp_f32 v96, v96
    v_exp_f32 v97, v97
    v_smfmac_f32_32x32x32_bf16 v[64:79], v[160:163], v[56:63], v19
    ds_read_b128 v[160:163], v16 offset:13536
    v_exp_f32 v98, v98
    v_exp_f32 v99, v99
    v_exp_f32 v100, v100
    v_exp_f32 v101, v101
    s_waitcnt lgkmcnt(1)
    v_mfma_f32_32x32x16_bf16 v[32:47], v[152:155], v[144:147], 0
    v_exp_f32 v102, v102
    v_exp_f32 v103, v103
    v_exp_f32 v104, v104
    v_exp_f32 v105, v105
    v_mfma_f32_32x32x8_bf16 v[32:47], v[150:151], v[148:149], v[32:47]
    v_exp_f32 v106, v106
    v_exp_f32 v107, v107
    v_exp_f32 v108, v108
    v_exp_f32 v109, v109
    v_smfmac_f32_32x32x32_bf16 v[128:143], v[156:159], v[96:103], v19
    v_exp_f32 v110, v110
    v_exp_f32 v111, v111
    s_setprio 1
    v_exp_f32 v112, v112
    v_exp_f32 v113, v113
    s_waitcnt lgkmcnt(0)
    v_smfmac_f32_32x32x32_bf16 v[128:143], v[160:163], v[104:111], v19
    s_add_u32 m0, s54, 0
    s_mov_b64 exec, s[58:59]
    buffer_load_dwordx4 v17, s[24:27], s52 offen sc1 lds
    s_add_u32 m0, s55, 0
    s_mov_b64 exec, s[60:61]
    buffer_load_dwordx4 v18, s[24:27], s53 offen sc1 lds
    s_mov_b64 exec, -1
    s_add_u32 s52, s52, 2048
    s_add_u32 s53, s53, 5120
    s_waitcnt vmcnt(2)
    ds_write_b32 v20, v22
    v_exp_f32 v114, v114
    v_exp_f32 v115, v115
    v_exp_f32 v116, v116
    v_exp_f32 v117, v117
    v_mfma_f32_32x32x16_bf16 v[48:63], v[152:155], v[8:11], 0
    ds_read_b128 v[152:155], v14 offset:24576
    v_exp_f32 v118, v118
    v_exp_f32 v119, v119
    v_exp_f32 v120, v120
    v_exp_f32 v121, v121
    v_mfma_f32_32x32x8_bf16 v[48:63], v[150:151], v[12:13], v[48:63]
    ds_read_b64 v[150:151], v15 offset:24576
    v_add_u32 v22, 1, v22
    v_exp_f32 v122, v122
    v_exp_f32 v123, v123
    v_exp_f32 v124, v124
    v_exp_f32 v125, v125
    v_smfmac_f32_32x32x32_bf16 v[64:79], v[156:159], v[112:119], v19
    ds_read_b128 v[156:159], v16 offset:23040
    v_exp_f32 v126, v126
    v_exp_f32 v127, v127
    s_branch gated_mix__mha_block__mixer_token_mlp__prompt_kernel_attl65
gated_mix__mha_block__mixer_token_mlp__prompt_kernel_join47:
    s_setprio 2
    v_exp_f32 v96, v96
    v_exp_f32 v97, v97
    v_smfmac_f32_32x32x32_bf16 v[64:79], v[160:163], v[56:63], v19
    ds_read_b128 v[160:163], v16 offset:13536
    v_exp_f32 v98, v98
    v_exp_f32 v99, v99
    v_exp_f32 v100, v100
    v_exp_f32 v101, v101
    v_exp_f32 v102, v102
    v_exp_f32 v103, v103
    v_exp_f32 v104, v104
    v_exp_f32 v105, v105
    s_waitcnt lgkmcnt(1)
    v_smfmac_f32_32x32x32_bf16 v[128:143], v[156:159], v[96:103], v19
    v_exp_f32 v106, v106
    v_exp_f32 v107, v107
    v_exp_f32 v108, v108
    v_exp_f32 v109, v109
    v_exp_f32 v110, v110
    v_exp_f32 v111, v111
    v_exp_f32 v112, v112
    v_exp_f32 v113, v113
    s_waitcnt lgkmcnt(0)
    v_smfmac_f32_32x32x32_bf16 v[128:143], v[160:163], v[104:111], v19
    s_setprio 1
    v_exp_f32 v114, v114
    v_exp_f32 v115, v115
    v_exp_f32 v116, v116
    v_exp_f32 v117, v117
    v_exp_f32 v118, v118
    v_exp_f32 v119, v119
    v_exp_f32 v120, v120
    v_exp_f32 v121, v121
    v_smfmac_f32_32x32x32_bf16 v[64:79], v[156:159], v[112:119], v19
    v_add_u32 v22, 1, v22
    v_exp_f32 v122, v122
    ds_write_b128 v80, v[128:131] offset:0
    ds_write_b128 v80, v[132:135] offset:1024
    ds_write_b128 v80, v[136:139] offset:2048
    ds_write_b32 v85, v140 offset:3072
    v_exp_f32 v123, v123
    v_exp_f32 v124, v124
    v_exp_f32 v125, v125
    v_exp_f32 v126, v126
    v_exp_f32 v127, v127
    s_waitcnt vmcnt(0) lgkmcnt(0)
    ds_write_b32 v20, v22
    v_smfmac_f32_32x32x32_bf16 v[64:79], v[160:163], v[120:127], v19
    s_mov_b32 s45, 800000
gated_mix__mha_block__mixer_token_mlp__prompt_kernel_spin82:
    ds_read_b32 v87, v82 offset:0
    s_waitcnt lgkmcnt(0)
    v_cmp_gt_u32 vcc, 19, v87
    s_cbranch_vccz gated_mix__mha_block__mixer_token_mlp__prompt_kernel_spind83
    s_sleep 0
    s_sub_u32 s45, s45, 1
    s_cbranch_scc0 gated_mix__mha_block__mixer_token_mlp__prompt_kernel_spin82
gated_mix__mha_block__mixer_token_mlp__prompt_kernel_spind83:
    s_setprio 3
    ds_read_b128 v[128:131], v81 offset:0
    ds_read_b128 v[132:135], v81 offset:1024
    ds_read_b128 v[136:139], v81 offset:2048
    ds_read_b32 v140, v86 offset:3072
    v_add_u32 v22, 1, v22
    s_waitcnt lgkmcnt(0)
    ds_write_b32 v20, v22
    v_add_f32 v76, v76, v140
.p2align 3
    v_pk_add_f32 v[64:65], v[64:65], v[128:129]
    v_pk_add_f32 v[66:67], v[66:67], v[130:131]
    v_pk_add_f32 v[68:69], v[68:69], v[132:133]
    v_pk_add_f32 v[70:71], v[70:71], v[134:135]
    v_pk_add_f32 v[72:73], v[72:73], v[136:137]
    v_pk_add_f32 v[74:75], v[74:75], v[138:139]
    v_cndmask_b32 v87, v72, v76, s[72:73]
    v_pk_mul_f32 v[88:89], v[64:65], 0
    v_pk_fma_f32 v[88:89], v[66:67], 0, v[88:89]
    v_pk_fma_f32 v[88:89], v[68:69], 0, v[88:89]
    v_pk_fma_f32 v[88:89], v[70:71], 0, v[88:89]
    v_pk_fma_f32 v[88:89], v[72:73], 0, v[88:89]
    v_pk_fma_f32 v[88:89], v[74:75], 0, v[88:89]
    v_add_f32 v88, v88, v89
    v_add_f32 v88, v88, v87
    v_med3_f32 v89, v88, s70, v93
    v_cmp_neq_f32 vcc, v89, v88
    s_cbranch_vccnz gated_mix__mha_block__mixer_token_mlp__prompt_kernel_slow84
gated_mix__mha_block__mixer_token_mlp__prompt_kernel_norm85:
    v_rcp_f32 v88, v87
    s_nop 0
    v_mul_f32 v88, v88, v31
.p2align 3
    v_pk_mul_f32 v[64:65], v[64:65], v[88:89] op_sel_hi:[1,0]
    v_pk_mul_f32 v[66:67], v[66:67], v[88:89] op_sel_hi:[1,0]
    v_pk_mul_f32 v[68:69], v[68:69], v[88:89] op_sel_hi:[1,0]
    v_pk_mul_f32 v[70:71], v[70:71], v[88:89] op_sel_hi:[1,0]
    v_pk_mul_f32 v[72:73], v[72:73], v[88:89] op_sel_hi:[1,0]
    v_pk_mul_f32 v[74:75], v[74:75], v[88:89] op_sel_hi:[1,0]
    v_cvt_pk_bf16_f32 v32, v64, v65
    v_cvt_pk_bf16_f32 v33, v66, v67
    v_cvt_pk_bf16_f32 v34, v68, v69
    v_cvt_pk_bf16_f32 v35, v70, v71
    v_cvt_pk_bf16_f32 v36, v72, v73
    v_cvt_pk_bf16_f32 v37, v74, v75
    buffer_store_dwordx4 v[32:35], v83, s[24:27], s64 offen sc1
    s_mov_b32 exec_hi, 0
    buffer_store_dwordx2 v[36:37], v92, s[24:27], s65 offen sc1
    s_mov_b64 exec, 1
    s_waitcnt vmcnt(0)
    buffer_atomic_add v95, v94, s[24:27], s66 offen sc1
    s_endpgm
gated_mix__mha_block__mixer_token_mlp__prompt_kernel_ool49:
    s_mov_b32 s45, 800000
gated_mix__mha_block__mixer_token_mlp__prompt_kernel_spin51:
    ds_read_b32 v30, v21 offset:0
    s_waitcnt lgkmcnt(0)
    v_cmp_gt_u32 vcc, s3, v30
    s_cbranch_vccz gated_mix__mha_block__mixer_token_mlp__prompt_kernel_spind52
    s_sleep 1
    s_sub_u32 s45, s45, 1
    s_cbranch_scc0 gated_mix__mha_block__mixer_token_mlp__prompt_kernel_spin51
gated_mix__mha_block__mixer_token_mlp__prompt_kernel_spind52:
    s_branch gated_mix__mha_block__mixer_token_mlp__prompt_kernel_back50
gated_mix__mha_block__mixer_token_mlp__prompt_kernel_ool53:
    s_mov_b32 s45, 800000
gated_mix__mha_block__mixer_token_mlp__prompt_kernel_spin55:
    ds_read_b32 v30, v21 offset:0
    s_waitcnt lgkmcnt(0)
    v_cmp_gt_u32 vcc, s3, v30
    s_cbranch_vccz gated_mix__mha_block__mixer_token_mlp__prompt_kernel_spind56
    s_sleep 1
    s_sub_u32 s45, s45, 1
    s_cbranch_scc0 gated_mix__mha_block__mixer_token_mlp__prompt_kernel_spin55
gated_mix__mha_block__mixer_token_mlp__prompt_kernel_spind56:
    s_branch gated_mix__mha_block__mixer_token_mlp__prompt_kernel_back54
gated_mix__mha_block__mixer_token_mlp__prompt_kernel_ool57:
    s_mov_b32 s45, 800000
gated_mix__mha_block__mixer_token_mlp__prompt_kernel_spin59:
    ds_read_b32 v30, v21 offset:0
    s_waitcnt lgkmcnt(0)
    v_cmp_gt_u32 vcc, s3, v30
    s_cbranch_vccz gated_mix__mha_block__mixer_token_mlp__prompt_kernel_spind60
    s_sleep 1
    s_sub_u32 s45, s45, 1
    s_cbranch_scc0 gated_mix__mha_block__mixer_token_mlp__prompt_kernel_spin59
gated_mix__mha_block__mixer_token_mlp__prompt_kernel_spind60:
    s_branch gated_mix__mha_block__mixer_token_mlp__prompt_kernel_back58
gated_mix__mha_block__mixer_token_mlp__prompt_kernel_ool61:
    s_mov_b32 s45, 800000
gated_mix__mha_block__mixer_token_mlp__prompt_kernel_spin63:
    ds_read_b32 v30, v21 offset:0
    s_waitcnt lgkmcnt(0)
    v_cmp_gt_u32 vcc, s3, v30
    s_cbranch_vccz gated_mix__mha_block__mixer_token_mlp__prompt_kernel_spind64
    s_sleep 1
    s_sub_u32 s45, s45, 1
    s_cbranch_scc0 gated_mix__mha_block__mixer_token_mlp__prompt_kernel_spin63
gated_mix__mha_block__mixer_token_mlp__prompt_kernel_spind64:
    s_branch gated_mix__mha_block__mixer_token_mlp__prompt_kernel_back62
gated_mix__mha_block__mixer_token_mlp__prompt_kernel_ool66:
    s_mov_b32 s45, 800000
gated_mix__mha_block__mixer_token_mlp__prompt_kernel_spin68:
    ds_read_b32 v30, v21 offset:0
    s_waitcnt lgkmcnt(0)
    v_cmp_gt_u32 vcc, s3, v30
    s_cbranch_vccz gated_mix__mha_block__mixer_token_mlp__prompt_kernel_spind69
    s_sleep 1
    s_sub_u32 s45, s45, 1
    s_cbranch_scc0 gated_mix__mha_block__mixer_token_mlp__prompt_kernel_spin68
gated_mix__mha_block__mixer_token_mlp__prompt_kernel_spind69:
    s_branch gated_mix__mha_block__mixer_token_mlp__prompt_kernel_back67
gated_mix__mha_block__mixer_token_mlp__prompt_kernel_ool70:
    s_mov_b32 s45, 800000
gated_mix__mha_block__mixer_token_mlp__prompt_kernel_spin72:
    ds_read_b32 v30, v21 offset:0
    s_waitcnt lgkmcnt(0)
    v_cmp_gt_u32 vcc, s3, v30
    s_cbranch_vccz gated_mix__mha_block__mixer_token_mlp__prompt_kernel_spind73
    s_sleep 1
    s_sub_u32 s45, s45, 1
    s_cbranch_scc0 gated_mix__mha_block__mixer_token_mlp__prompt_kernel_spin72
gated_mix__mha_block__mixer_token_mlp__prompt_kernel_spind73:
    s_branch gated_mix__mha_block__mixer_token_mlp__prompt_kernel_back71
gated_mix__mha_block__mixer_token_mlp__prompt_kernel_ool74:
    s_mov_b32 s45, 800000
gated_mix__mha_block__mixer_token_mlp__prompt_kernel_spin76:
    ds_read_b32 v30, v21 offset:0
    s_waitcnt lgkmcnt(0)
    v_cmp_gt_u32 vcc, s3, v30
    s_cbranch_vccz gated_mix__mha_block__mixer_token_mlp__prompt_kernel_spind77
    s_sleep 1
    s_sub_u32 s45, s45, 1
    s_cbranch_scc0 gated_mix__mha_block__mixer_token_mlp__prompt_kernel_spin76
gated_mix__mha_block__mixer_token_mlp__prompt_kernel_spind77:
    s_branch gated_mix__mha_block__mixer_token_mlp__prompt_kernel_back75
gated_mix__mha_block__mixer_token_mlp__prompt_kernel_ool78:
    s_mov_b32 s45, 800000
gated_mix__mha_block__mixer_token_mlp__prompt_kernel_spin80:
    ds_read_b32 v30, v21 offset:0
    s_waitcnt lgkmcnt(0)
    v_cmp_gt_u32 vcc, s3, v30
    s_cbranch_vccz gated_mix__mha_block__mixer_token_mlp__prompt_kernel_spind81
    s_sleep 1
    s_sub_u32 s45, s45, 1
    s_cbranch_scc0 gated_mix__mha_block__mixer_token_mlp__prompt_kernel_spin80
gated_mix__mha_block__mixer_token_mlp__prompt_kernel_spind81:
    s_branch gated_mix__mha_block__mixer_token_mlp__prompt_kernel_back79
gated_mix__mha_block__mixer_token_mlp__prompt_kernel_slow84:
    s_waitcnt vmcnt(0) lgkmcnt(0)
    v_mov_b32 v88, 0xff800000
    s_mov_b32 s67, s62
    s_mov_b32 s69, 64
gated_mix__mha_block__mixer_token_mlp__prompt_kernel_slowa86:
    buffer_load_dwordx4 v[152:155], v25, s[24:27], s67 offen sc1
    buffer_load_dwordx2 v[150:151], v26, s[24:27], s67 offen sc1
    s_waitcnt vmcnt(0)
    v_mfma_f32_32x32x16_bf16 v[32:47], v[152:155], v[8:11], 0
    v_mfma_f32_32x32x8_bf16 v[32:47], v[150:151], v[12:13], v[32:47]
    s_add_u32 s67, s67, 512
    s_nop 15
    v_max3_f32 v88, v88, v32, v33
    v_max3_f32 v88, v88, v34, v35
    v_max3_f32 v88, v88, v36, v37
    v_max3_f32 v88, v88, v38, v39
    v_max3_f32 v88, v88, v40, v41
    v_max3_f32 v88, v88, v42, v43
    v_max3_f32 v88, v88, v44, v45
    v_max3_f32 v88, v88, v46, v47
    s_sub_u32 s69, s69, 1
    s_cmp_lg_u32 s69, 0
    s_cbranch_scc1 gated_mix__mha_block__mixer_token_mlp__prompt_kernel_slowa86
    v_mov_b32 v89, v88
    s_nop 1
    v_permlane32_swap_b32 v88, v89
    s_nop 1
    v_max_f32 v88, v88, v89
    v_mul_u32_u24 v89, 320, v24
    v_lshl_add_u32 v89, v23, 4, v89
    v_sub_f32 v48, 0, v88
    v_mov_b32 v64, 0
    v_sub_f32 v49, 0, v88
    v_mov_b32 v65, 0
    v_sub_f32 v50, 0, v88
    v_mov_b32 v66, 0
    v_sub_f32 v51, 0, v88
    v_mov_b32 v67, 0
    v_sub_f32 v52, 0, v88
    v_mov_b32 v68, 0
    v_sub_f32 v53, 0, v88
    v_mov_b32 v69, 0
    v_sub_f32 v54, 0, v88
    v_mov_b32 v70, 0
    v_sub_f32 v55, 0, v88
    v_mov_b32 v71, 0
    v_sub_f32 v56, 0, v88
    v_mov_b32 v72, 0
    v_sub_f32 v57, 0, v88
    v_mov_b32 v73, 0
    v_sub_f32 v58, 0, v88
    v_mov_b32 v74, 0
    v_sub_f32 v59, 0, v88
    v_mov_b32 v75, 0
    v_sub_f32 v60, 0, v88
    v_mov_b32 v76, 0
    v_sub_f32 v61, 0, v88
    v_mov_b32 v77, 0
    v_sub_f32 v62, 0, v88
    v_mov_b32 v78, 0
    v_sub_f32 v63, 0, v88
    v_mov_b32 v79, 0
    v_mov_b32 v156, 0x3f803f80
    v_mov_b32 v160, 0x3f803f80
    v_mov_b32 v157, 0x3f803f80
    v_mov_b32 v161, 0x3f803f80
    v_mov_b32 v158, 0x3f803f80
    v_mov_b32 v162, 0x3f803f80
    v_mov_b32 v159, 0x3f803f80
    v_mov_b32 v163, 0x3f803f80
    s_mov_b32 s67, s62
    s_mov_b32 s68, s63
    s_mov_b32 s69, 64
    s_mov_b32 s74, 0xfffff
    s_mov_b32 s75, 0xfffff
gated_mix__mha_block__mixer_token_mlp__prompt_kernel_slowb87:
    buffer_load_dwordx4 v[152:155], v25, s[24:27], s67 offen sc1
    buffer_load_dwordx2 v[150:151], v26, s[24:27], s67 offen sc1
    s_mov_b64 exec, s[74:75]
    buffer_load_dwordx4 v[156:159], v89, s[24:27], s68 offen sc1
    buffer_load_dwordx4 v[160:163], v89, s[24:27], s68 offen offset:640 sc1
    s_mov_b64 exec, -1
    s_waitcnt vmcnt(0)
    v_mfma_f32_32x32x16_bf16 v[32:47], v[152:155], v[8:11], v[48:63]
    v_mfma_f32_32x32x8_bf16 v[32:47], v[150:151], v[12:13], v[32:47]
    s_add_u32 s67, s67, 512
    s_add_u32 s68, s68, 1280
    s_nop 15
    v_exp_f32 v32, v32
    v_exp_f32 v33, v33
    v_exp_f32 v34, v34
    v_exp_f32 v35, v35
    v_exp_f32 v36, v36
    v_exp_f32 v37, v37
    v_exp_f32 v38, v38
    v_exp_f32 v39, v39
    v_exp_f32 v40, v40
    v_exp_f32 v41, v41
    v_exp_f32 v42, v42
    v_exp_f32 v43, v43
    v_exp_f32 v44, v44
    v_exp_f32 v45, v45
    v_exp_f32 v46, v46
    v_exp_f32 v47, v47
    s_nop 1
    v_smfmac_f32_32x32x32_bf16 v[64:79], v[156:159], v[32:39], v19
    v_smfmac_f32_32x32x32_bf16 v[64:79], v[160:163], v[40:47], v19
    s_sub_u32 s69, s69, 1
    s_cmp_lg_u32 s69, 0
    s_nop 7
    s_cbranch_scc1 gated_mix__mha_block__mixer_token_mlp__prompt_kernel_slowb87
    s_nop 15
    v_cndmask_b32 v87, v72, v76, s[72:73]
    s_branch gated_mix__mha_block__mixer_token_mlp__prompt_kernel_norm85
gated_mix__mha_block__mixer_token_mlp__prompt_kernel_grole2:
    s_setprio 0
    s_mul_i32 s49, s48, 25600
    s_lshl_b32 s54, s48, 2
    s_add_u32 s54, s54, 163616
    v_mov_b32 v160, s54
    v_lshrrev_b32 v48, 4, v0
    v_and_b32 v49, 15, v0
    v_lshrrev_b32 v50, 5, v0
    v_and_b32 v51, 31, v0
    v_and_b32 v52, 3, v0
    v_bfe_u32 v53, v0, 2, 2
    v_lshlrev_b32 v161, 2, v52
    v_add_u32 v161, 163616, v161
    v_mov_b32 v164, 163584
    v_lshrrev_b32 v30, 3, v0
    v_and_b32 v31, 7, v0
    v_lshlrev_b32 v13, 1, v48
    v_xor_b32 v13, v13, v31
    v_lshlrev_b32 v30, 12, v30
    v_lshl_add_u32 v13, v13, 4, v30
    s_mul_i32 s64, s48, 1572864
    s_barrier
    s_lshl_b32 s54, s62, 7
    s_add_u32 s64, s64, s54
    s_mul_i32 s65, s48, 491520
    s_mul_i32 s54, s63, 1280
    s_add_u32 s65, s65, s54
    s_add_u32 s65, s65, 10485760
    v_mul_u32_u24 v14, 10240, v48
    v_lshl_add_u32 v14, v49, 4, v14
    v_bfe_u32 v30, v0, 2, 3
    v_lshrrev_b32 v31, 2, v0
    v_lshlrev_b32 v31, 7, v31
    v_lshl_add_u32 v31, v52, 3, v31
    v_add_u32 v31, s49, v31
    v_lshrrev_b32 v32, 1, v30
    v_xor_b32 v32, s48, v32
    v_xor_b32 v33, 0, v32
    v_lshl_add_u32 v15, v33, 5, v31
    v_xor_b32 v33, 1, v32
    v_lshl_add_u32 v16, v33, 5, v31
    v_xor_b32 v33, 2, v32
    s_barrier
    v_lshl_add_u32 v17, v33, 5, v31
    v_xor_b32 v33, 3, v32
    v_lshl_add_u32 v18, v33, 5, v31
    v_lshlrev_b32 v12, 15, v48
    v_lshl_add_u32 v12, v49, 4, v12
    v_add_u32 v19, s66, v49
    v_mul_u32_u24 v19, 1280, v19
    v_lshl_add_u32 v19, v48, 3, v19
    v_add_u32 v31, 0, v0
    v_mul_u32_u24 v32, 6554, v31
    v_lshrrev_b32 v32, 16, v32
    v_mul_u32_u24 v32, 1120, v32
    v_lshl_add_u32 v1, v31, 4, v32
    v_add_u32 v31, 64, v0
    v_mul_u32_u24 v32, 6554, v31
    v_lshrrev_b32 v32, 16, v32
    v_mul_u32_u24 v32, 1120, v32
    v_lshl_add_u32 v2, v31, 4, v32
    v_add_u32 v31, 128, v0
    v_mul_u32_u24 v32, 6554, v31
    s_barrier
    v_lshrrev_b32 v32, 16, v32
    v_mul_u32_u24 v32, 1120, v32
    v_lshl_add_u32 v3, v31, 4, v32
    v_add_u32 v31, 192, v0
    v_mul_u32_u24 v32, 6554, v31
    v_lshrrev_b32 v32, 16, v32
    v_mul_u32_u24 v32, 1120, v32
    v_lshl_add_u32 v4, v31, 4, v32
    v_add_u32 v31, 256, v0
    v_mul_u32_u24 v32, 6554, v31
    v_lshrrev_b32 v32, 16, v32
    v_mul_u32_u24 v32, 1120, v32
    v_lshl_add_u32 v5, v31, 4, v32
    v_mul_u32_u24 v31, 20, v50
    v_add_u32 v31, v31, v30
    v_mul_u32_u24 v31, 160, v31
    v_lshl_add_u32 v6, v52, 3, v31
    v_add_u32 v7, 51200, v6
    v_mul_u32_u24 v31, 40, v48
    v_add_u32 v31, v31, v53
    s_barrier
    v_add_u32 v31, 16, v31
    v_mul_u32_u24 v31, 160, v31
    v_lshl_add_u32 v31, v52, 3, v31
    v_and_b32 v32, 1, v48
    v_mul_u32_u24 v32, 3200, v32
    v_sub_u32 v9, v31, v32
    v_add_u32 v9, 3200, v9
    v_add_u32 v8, v31, v32
    v_add_u32 v10, 51200, v8
    v_add_u32 v11, 51200, v9
    s_and_b32 s54, s52, 3
    s_lshl_b32 s54, s54, 1
    v_lshrrev_b32 v32, 4, v0
    v_bfe_u32 v33, v0, 2, 2
    v_lshl_add_u32 v24, v32, 3, v33
    v_lshlrev_b32 v24, 8, v24
    v_and_b32 v32, 1, v32
    v_lshl_add_u32 v32, v33, 1, v32
    v_xor_b32 v32, s54, v32
    v_lshl_add_u32 v24, v32, 5, v24
    s_barrier
    v_and_b32 v32, 3, v0
    v_lshl_add_u32 v24, v32, 3, v24
    v_add_u32 v24, 65536, v24
    v_xor_b32 v25, 32, v24
    v_xor_b32 v26, 64, v24
    v_xor_b32 v27, 96, v24
    s_xor_b32 s54, s52, s51
    s_and_b32 s54, s54, 3
    s_lshl_b32 s54, s54, 6
    s_add_u32 s54, s54, 16384
    v_xor_b32 v28, s54, v24
    v_xor_b32 v29, s54, v25
    v_xor_b32 v30, s54, v26
    v_xor_b32 v31, s54, v27
    v_pk_mov_b32 v[80:81], 0, 0
    v_pk_mov_b32 v[82:83], 0, 0
    v_pk_mov_b32 v[84:85], 0, 0
    v_pk_mov_b32 v[86:87], 0, 0
    v_pk_mov_b32 v[88:89], 0, 0
    v_pk_mov_b32 v[90:91], 0, 0
    s_barrier
    v_pk_mov_b32 v[92:93], 0, 0
    v_pk_mov_b32 v[94:95], 0, 0
    v_pk_mov_b32 v[96:97], 0, 0
    v_pk_mov_b32 v[98:99], 0, 0
    v_pk_mov_b32 v[100:101], 0, 0
    v_pk_mov_b32 v[102:103], 0, 0
    v_pk_mov_b32 v[104:105], 0, 0
    v_pk_mov_b32 v[106:107], 0, 0
    v_pk_mov_b32 v[108:109], 0, 0
    v_pk_mov_b32 v[110:111], 0, 0
    v_pk_mov_b32 v[112:113], 0, 0
    v_pk_mov_b32 v[114:115], 0, 0
    v_pk_mov_b32 v[116:117], 0, 0
    v_pk_mov_b32 v[118:119], 0, 0
    v_pk_mov_b32 v[120:121], 0, 0
    v_pk_mov_b32 v[122:123], 0, 0
    v_pk_mov_b32 v[124:125], 0, 0
    v_pk_mov_b32 v[126:127], 0, 0
    s_waitcnt vmcnt(0)
    v_lshlrev_b32 v64, 16, v54
    s_barrier
    v_and_b32 v65, 0xffff0000, v54
    v_lshlrev_b32 v66, 16, v55
    v_and_b32 v67, 0xffff0000, v55
    v_lshlrev_b32 v68, 16, v56
    v_and_b32 v69, 0xffff0000, v56
    v_lshlrev_b32 v70, 16, v57
    v_and_b32 v71, 0xffff0000, v57
    v_lshlrev_b32 v72, 16, v54
    v_and_b32 v73, 0xffff0000, v54
    v_lshlrev_b32 v74, 16, v55
    v_and_b32 v75, 0xffff0000, v55
    v_lshlrev_b32 v76, 16, v56
    v_and_b32 v77, 0xffff0000, v56
    v_lshlrev_b32 v78, 16, v57
    v_and_b32 v79, 0xffff0000, v57
    v_lshlrev_b32 v20, 16, v62
    s_barrier
    s_cmp_eq_u32 s47, 15
    s_cbranch_scc1 gated_mix__mha_block__mixer_token_mlp__prompt_kernel_g1skip88
    s_setprio 1
    ds_read_b64_tr_b16 v[32:33], v24 offset:0
    ds_read_b64_tr_b16 v[34:35], v24 offset:1024
    ds_read_b64_tr_b16 v[48:49], v28 offset:0
    ds_read_b64_tr_b16 v[50:51], v28 offset:1024
    ds_read_b64_tr_b16 v[36:37], v25 offset:0
    ds_read_b64_tr_b16 v[38:39], v25 offset:1024
    ds_read_b64_tr_b16 v[40:41], v26 offset:0
    ds_read_b64_tr_b16 v[42:43], v26 offset:1024
    ds_read_b64_tr_b16 v[44:45], v27 offset:0
    ds_read_b64_tr_b16 v[46:47], v27 offset:1024
    ds_read_b64_tr_b16 v[52:53], v29 offset:0
    ds_read_b64_tr_b16 v[54:55], v29 offset:1024
    ds_read_b64_tr_b16 v[56:57], v30 offset:0
    ds_read_b64_tr_b16 v[58:59], v30 offset:1024
    ds_read_b64_tr_b16 v[60:61], v31 offset:0
    ds_read_b64_tr_b16 v[62:63], v31 offset:1024
    s_mov_b32 s54, 4
gated_mix__mha_block__mixer_token_mlp__prompt_kernel_gl90:
    s_waitcnt lgkmcnt(6)
    v_mfma_f32_16x16x32_bf16 v[64:67], v[48:51], v[32:35], v[64:67]
    ds_read_b64_tr_b16 v[128:129], v24 offset:8192
    v_mfma_f32_16x16x32_bf16 v[72:75], v[48:51], v[36:39], v[72:75]
    ds_read_b64_tr_b16 v[130:131], v24 offset:9216
    v_mfma_f32_16x16x32_bf16 v[96:99], v[48:51], v[40:43], v[96:99]
    ds_read_b64_tr_b16 v[144:145], v28 offset:8192
    v_mfma_f32_16x16x32_bf16 v[104:107], v[48:51], v[44:47], v[104:107]
    ds_read_b64_tr_b16 v[146:147], v28 offset:9216
    s_waitcnt lgkmcnt(8)
    v_mfma_f32_16x16x32_bf16 v[108:111], v[52:55], v[44:47], v[108:111]
    ds_read_b64_tr_b16 v[132:133], v25 offset:8192
    v_mfma_f32_16x16x32_bf16 v[100:103], v[52:55], v[40:43], v[100:103]
    ds_read_b64_tr_b16 v[134:135], v25 offset:9216
    v_mfma_f32_16x16x32_bf16 v[76:79], v[52:55], v[36:39], v[76:79]
    ds_read_b64_tr_b16 v[136:137], v26 offset:8192
    v_mfma_f32_16x16x32_bf16 v[68:71], v[52:55], v[32:35], v[68:71]
    ds_read_b64_tr_b16 v[138:139], v26 offset:9216
    s_waitcnt lgkmcnt(8)
    v_mfma_f32_16x16x32_bf16 v[80:83], v[56:59], v[32:35], v[80:83]
    ds_read_b64_tr_b16 v[140:141], v27 offset:8192
    v_mfma_f32_16x16x32_bf16 v[88:91], v[56:59], v[36:39], v[88:91]
    ds_read_b64_tr_b16 v[142:143], v27 offset:9216
    v_mfma_f32_16x16x32_bf16 v[112:115], v[56:59], v[40:43], v[112:115]
    ds_read_b64_tr_b16 v[148:149], v29 offset:8192
    v_mfma_f32_16x16x32_bf16 v[120:123], v[56:59], v[44:47], v[120:123]
    ds_read_b64_tr_b16 v[150:151], v29 offset:9216
    v_mfma_f32_16x16x32_bf16 v[124:127], v[60:63], v[44:47], v[124:127]
    ds_read_b64_tr_b16 v[152:153], v30 offset:8192
    v_mfma_f32_16x16x32_bf16 v[116:119], v[60:63], v[40:43], v[116:119]
    ds_read_b64_tr_b16 v[154:155], v30 offset:9216
    v_mfma_f32_16x16x32_bf16 v[92:95], v[60:63], v[36:39], v[92:95]
    ds_read_b64_tr_b16 v[156:157], v31 offset:8192
    v_mfma_f32_16x16x32_bf16 v[84:87], v[60:63], v[32:35], v[84:87]
    ds_read_b64_tr_b16 v[158:159], v31 offset:9216
    s_waitcnt lgkmcnt(6)
    v_mfma_f32_16x16x32_bf16 v[64:67], v[144:147], v[128:131], v[64:67]
    s_barrier
    ds_read_b64_tr_b16 v[32:33], v24 offset:32768
    v_mfma_f32_16x16x32_bf16 v[72:75], v[144:147], v[132:135], v[72:75]
    ds_read_b64_tr_b16 v[34:35], v24 offset:33792
    v_mfma_f32_16x16x32_bf16 v[96:99], v[144:147], v[136:139], v[96:99]
    ds_read_b64_tr_b16 v[48:49], v28 offset:32768
    v_mfma_f32_16x16x32_bf16 v[104:107], v[144:147], v[140:143], v[104:107]
    ds_read_b64_tr_b16 v[50:51], v28 offset:33792
    s_waitcnt lgkmcnt(8)
    v_mfma_f32_16x16x32_bf16 v[108:111], v[148:151], v[140:143], v[108:111]
    ds_read_b64_tr_b16 v[36:37], v25 offset:32768
    v_mfma_f32_16x16x32_bf16 v[100:103], v[148:151], v[136:139], v[100:103]
    ds_read_b64_tr_b16 v[38:39], v25 offset:33792
    v_mfma_f32_16x16x32_bf16 v[76:79], v[148:151], v[132:135], v[76:79]
    ds_read_b64_tr_b16 v[40:41], v26 offset:32768
    v_mfma_f32_16x16x32_bf16 v[68:71], v[148:151], v[128:131], v[68:71]
    ds_read_b64_tr_b16 v[42:43], v26 offset:33792
    s_waitcnt lgkmcnt(8)
    v_mfma_f32_16x16x32_bf16 v[80:83], v[152:155], v[128:131], v[80:83]
    ds_read_b64_tr_b16 v[44:45], v27 offset:32768
    v_mfma_f32_16x16x32_bf16 v[88:91], v[152:155], v[132:135], v[88:91]
    ds_read_b64_tr_b16 v[46:47], v27 offset:33792
    v_mfma_f32_16x16x32_bf16 v[112:115], v[152:155], v[136:139], v[112:115]
    ds_read_b64_tr_b16 v[52:53], v29 offset:32768
    v_mfma_f32_16x16x32_bf16 v[120:123], v[152:155], v[140:143], v[120:123]
    ds_read_b64_tr_b16 v[54:55], v29 offset:33792
    v_mfma_f32_16x16x32_bf16 v[124:127], v[156:159], v[140:143], v[124:127]
    ds_read_b64_tr_b16 v[56:57], v30 offset:32768
    v_mfma_f32_16x16x32_bf16 v[116:119], v[156:159], v[136:139], v[116:119]
    ds_read_b64_tr_b16 v[58:59], v30 offset:33792
    v_mfma_f32_16x16x32_bf16 v[92:95], v[156:159], v[132:135], v[92:95]
    ds_read_b64_tr_b16 v[60:61], v31 offset:32768
    v_mfma_f32_16x16x32_bf16 v[84:87], v[156:159], v[128:131], v[84:87]
    ds_read_b64_tr_b16 v[62:63], v31 offset:33792
    s_waitcnt lgkmcnt(6)
    v_mfma_f32_16x16x32_bf16 v[64:67], v[48:51], v[32:35], v[64:67]
    ds_read_b64_tr_b16 v[128:129], v24 offset:40960
    v_mfma_f32_16x16x32_bf16 v[72:75], v[48:51], v[36:39], v[72:75]
    ds_read_b64_tr_b16 v[130:131], v24 offset:41984
    v_mfma_f32_16x16x32_bf16 v[96:99], v[48:51], v[40:43], v[96:99]
    ds_read_b64_tr_b16 v[144:145], v28 offset:40960
    v_mfma_f32_16x16x32_bf16 v[104:107], v[48:51], v[44:47], v[104:107]
    ds_read_b64_tr_b16 v[146:147], v28 offset:41984
    s_waitcnt lgkmcnt(8)
    v_mfma_f32_16x16x32_bf16 v[108:111], v[52:55], v[44:47], v[108:111]
    ds_read_b64_tr_b16 v[132:133], v25 offset:40960
    v_mfma_f32_16x16x32_bf16 v[100:103], v[52:55], v[40:43], v[100:103]
    ds_read_b64_tr_b16 v[134:135], v25 offset:41984
    v_mfma_f32_16x16x32_bf16 v[76:79], v[52:55], v[36:39], v[76:79]
    ds_read_b64_tr_b16 v[136:137], v26 offset:40960
    v_mfma_f32_16x16x32_bf16 v[68:71], v[52:55], v[32:35], v[68:71]
    ds_read_b64_tr_b16 v[138:139], v26 offset:41984
    s_waitcnt lgkmcnt(8)
    v_mfma_f32_16x16x32_bf16 v[80:83], v[56:59], v[32:35], v[80:83]
    ds_read_b64_tr_b16 v[140:141], v27 offset:40960
    v_mfma_f32_16x16x32_bf16 v[88:91], v[56:59], v[36:39], v[88:91]
    ds_read_b64_tr_b16 v[142:143], v27 offset:41984
    v_mfma_f32_16x16x32_bf16 v[112:115], v[56:59], v[40:43], v[112:115]
    ds_read_b64_tr_b16 v[148:149], v29 offset:40960
    v_mfma_f32_16x16x32_bf16 v[120:123], v[56:59], v[44:47], v[120:123]
    ds_read_b64_tr_b16 v[150:151], v29 offset:41984
    v_mfma_f32_16x16x32_bf16 v[124:127], v[60:63], v[44:47], v[124:127]
    ds_read_b64_tr_b16 v[152:153], v30 offset:40960
    v_mfma_f32_16x16x32_bf16 v[116:119], v[60:63], v[40:43], v[116:119]
    ds_read_b64_tr_b16 v[154:155], v30 offset:41984
    v_mfma_f32_16x16x32_bf16 v[92:95], v[60:63], v[36:39], v[92:95]
    ds_read_b64_tr_b16 v[156:157], v31 offset:40960
    v_mfma_f32_16x16x32_bf16 v[84:87], v[60:63], v[32:35], v[84:87]
    ds_read_b64_tr_b16 v[158:159], v31 offset:41984
    s_waitcnt lgkmcnt(6)
    v_mfma_f32_16x16x32_bf16 v[64:67], v[144:147], v[128:131], v[64:67]
    s_cmp_eq_u32 s54, 1
    s_cbranch_scc1 gated_mix__mha_block__mixer_token_mlp__prompt_kernel_nb91
    s_barrier
gated_mix__mha_block__mixer_token_mlp__prompt_kernel_nb91:
    v_xor_b32 v24, 0x10000, v24
    ds_read_b64_tr_b16 v[32:33], v24 offset:0
    v_mfma_f32_16x16x32_bf16 v[72:75], v[144:147], v[132:135], v[72:75]
    ds_read_b64_tr_b16 v[34:35], v24 offset:1024
    v_mfma_f32_16x16x32_bf16 v[96:99], v[144:147], v[136:139], v[96:99]
    v_xor_b32 v28, 0x10000, v28
    ds_read_b64_tr_b16 v[48:49], v28 offset:0
    v_mfma_f32_16x16x32_bf16 v[104:107], v[144:147], v[140:143], v[104:107]
    ds_read_b64_tr_b16 v[50:51], v28 offset:1024
    s_waitcnt lgkmcnt(8)
    v_mfma_f32_16x16x32_bf16 v[108:111], v[148:151], v[140:143], v[108:111]
    v_xor_b32 v25, 0x10000, v25
    ds_read_b64_tr_b16 v[36:37], v25 offset:0
    v_mfma_f32_16x16x32_bf16 v[100:103], v[148:151], v[136:139], v[100:103]
    ds_read_b64_tr_b16 v[38:39], v25 offset:1024
    v_mfma_f32_16x16x32_bf16 v[76:79], v[148:151], v[132:135], v[76:79]
    v_xor_b32 v26, 0x10000, v26
    ds_read_b64_tr_b16 v[40:41], v26 offset:0
    v_mfma_f32_16x16x32_bf16 v[68:71], v[148:151], v[128:131], v[68:71]
    ds_read_b64_tr_b16 v[42:43], v26 offset:1024
    s_waitcnt lgkmcnt(8)
    v_mfma_f32_16x16x32_bf16 v[80:83], v[152:155], v[128:131], v[80:83]
    v_xor_b32 v27, 0x10000, v27
    ds_read_b64_tr_b16 v[44:45], v27 offset:0
    v_mfma_f32_16x16x32_bf16 v[88:91], v[152:155], v[132:135], v[88:91]
    ds_read_b64_tr_b16 v[46:47], v27 offset:1024
    v_mfma_f32_16x16x32_bf16 v[112:115], v[152:155], v[136:139], v[112:115]
    v_xor_b32 v29, 0x10000, v29
    ds_read_b64_tr_b16 v[52:53], v29 offset:0
    v_mfma_f32_16x16x32_bf16 v[120:123], v[152:155], v[140:143], v[120:123]
    ds_read_b64_tr_b16 v[54:55], v29 offset:1024
    v_mfma_f32_16x16x32_bf16 v[124:127], v[156:159], v[140:143], v[124:127]
    v_xor_b32 v30, 0x10000, v30
    ds_read_b64_tr_b16 v[56:57], v30 offset:0
    v_mfma_f32_16x16x32_bf16 v[116:119], v[156:159], v[136:139], v[116:119]
    ds_read_b64_tr_b16 v[58:59], v30 offset:1024
    v_mfma_f32_16x16x32_bf16 v[92:95], v[156:159], v[132:135], v[92:95]
    v_xor_b32 v31, 0x10000, v31
    ds_read_b64_tr_b16 v[60:61], v31 offset:0
    v_mfma_f32_16x16x32_bf16 v[84:87], v[156:159], v[128:131], v[84:87]
    ds_read_b64_tr_b16 v[62:63], v31 offset:1024
    s_sub_u32 s54, s54, 1
    s_cmp_lg_u32 s54, 0
    s_cbranch_scc1 gated_mix__mha_block__mixer_token_mlp__prompt_kernel_gl90
    s_setprio 3
    s_lshl_b32 s55, s3, 2
    s_lshl_b32 s57, s48, 11
    s_add_u32 s57, s57, 16777216
    v_lshlrev_b32 v29, 4, v0
    s_waitcnt lgkmcnt(0)
    v_mov_b32 v162, 1
    ds_write_b32 v160, v162
    s_xor_b32 s54, s50, 2
    s_add_u32 s54, s54, s55
    s_mul_i32 s54, s54, 24576
    s_add_u32 s54, s54, s57
    s_add_u32 s58, s54, 0
.p2align 3
    v_cvt_pk_bf16_f32 v32, v80, v81
    v_cvt_pk_bf16_f32 v33, v82, v83
    v_cvt_pk_bf16_f32 v34, v84, v85
    v_cvt_pk_bf16_f32 v35, v86, v87
    v_cvt_pk_bf16_f32 v36, v88, v89
    v_cvt_pk_bf16_f32 v37, v90, v91
    v_cvt_pk_bf16_f32 v38, v92, v93
    v_cvt_pk_bf16_f32 v39, v94, v95
    s_xor_b32 s54, s50, 1
    s_add_u32 s54, s54, s55
    s_mul_i32 s54, s54, 24576
    s_add_u32 s54, s54, s57
    s_add_u32 s59, s54, 8192
.p2align 3
    v_cvt_pk_bf16_f32 v40, v96, v97
    v_cvt_pk_bf16_f32 v41, v98, v99
    v_cvt_pk_bf16_f32 v42, v100, v101
    v_cvt_pk_bf16_f32 v43, v102, v103
    v_cvt_pk_bf16_f32 v44, v104, v105
    v_cvt_pk_bf16_f32 v45, v106, v107
    v_cvt_pk_bf16_f32 v46, v108, v109
    v_cvt_pk_bf16_f32 v47, v110, v111
    s_xor_b32 s54, s50, 3
    s_add_u32 s54, s54, s55
    s_mul_i32 s54, s54, 24576
    s_add_u32 s54, s54, s57
    s_add_u32 s60, s54, 16384
.p2align 3
    v_cvt_pk_bf16_f32 v48, v112, v113
    v_cvt_pk_bf16_f32 v49, v114, v115
    v_cvt_pk_bf16_f32 v50, v116, v117
    v_cvt_pk_bf16_f32 v51, v118, v119
    v_cvt_pk_bf16_f32 v52, v120, v121
    v_cvt_pk_bf16_f32 v53, v122, v123
    v_cvt_pk_bf16_f32 v54, v124, v125
    v_cvt_pk_bf16_f32 v55, v126, v127
    s_mov_b32 s45, 800000
gated_mix__mha_block__mixer_token_mlp__prompt_kernel_spin92:
    ds_read_b32 v165, v164 offset:0
    s_waitcnt lgkmcnt(0)
    v_cmp_gt_u32 vcc, 2, v165
    s_cbranch_vccz gated_mix__mha_block__mixer_token_mlp__prompt_kernel_spind93
    s_sleep 6
    s_sub_u32 s45, s45, 1
    s_cbranch_scc0 gated_mix__mha_block__mixer_token_mlp__prompt_kernel_spin92
gated_mix__mha_block__mixer_token_mlp__prompt_kernel_spind93:
    s_mov_b32 s45, 800000
gated_mix__mha_block__mixer_token_mlp__prompt_kernel_spin94:
    ds_read_b32 v163, v161 offset:0
    s_waitcnt lgkmcnt(0)
    v_cmp_gt_u32 vcc, 1, v163
    s_cbranch_vccz gated_mix__mha_block__mixer_token_mlp__prompt_kernel_spind95
    s_sleep 2
    s_sub_u32 s45, s45, 1
    s_cbranch_scc0 gated_mix__mha_block__mixer_token_mlp__prompt_kernel_spin94
gated_mix__mha_block__mixer_token_mlp__prompt_kernel_spind95:
    s_setprio 0
    buffer_store_dwordx4 v[32:35], v29, s[24:27], s58 offen sc1
    buffer_store_dwordx4 v[36:39], v29, s[24:27], s58 offen offset:1024 sc1
    buffer_store_dwordx4 v[40:43], v29, s[24:27], s59 offen sc1
    buffer_store_dwordx4 v[44:47], v29, s[24:27], s59 offen offset:1024 sc1
    buffer_store_dwordx4 v[48:51], v29, s[24:27], s60 offen sc1
    buffer_store_dwordx4 v[52:55], v29, s[24:27], s60 offen offset:1024 sc1
    s_setprio 3
    s_add_u32 s54, s55, s48
    s_mul_i32 s54, s54, 64
    s_add_u32 s54, s54, 15269888
    s_add_u32 s56, s55, s50
    s_mul_i32 s56, s56, 24576
    s_add_u32 s56, s56, s57
    s_mov_b64 exec, 1
    v_mov_b32 v30, 0
    v_mov_b32 v31, 1
    s_waitcnt vmcnt(0)
    buffer_atomic_add v31, v30, s[24:27], s54 offen sc0 sc1
    s_waitcnt vmcnt(0)
    v_add_u32 v31, 1, v31
    s_mov_b32 s45, 200000
    s_mov_b64 exec, 1
    s_branch gated_mix__mha_block__mixer_token_mlp__prompt_kernel_apollc98
gated_mix__mha_block__mixer_token_mlp__prompt_kernel_apoll96:
    s_mov_b64 exec, 1
    v_mov_b32 v30, 0
    v_mov_b32 v31, 0
    buffer_atomic_add v31, v30, s[24:27], s54 offen sc0 sc1
gated_mix__mha_block__mixer_token_mlp__prompt_kernel_apollc98:
    s_waitcnt vmcnt(0)
    v_cmp_gt_u32 vcc, 4, v31
    s_cbranch_vccz gated_mix__mha_block__mixer_token_mlp__prompt_kernel_apolld97
    s_sleep 4
    s_sub_u32 s45, s45, 1
    s_cbranch_scc0 gated_mix__mha_block__mixer_token_mlp__prompt_kernel_apoll96
gated_mix__mha_block__mixer_token_mlp__prompt_kernel_apolld97:
    s_mov_b64 exec, -1
    buffer_load_dwordx4 v[32:35], v29, s[24:27], s56 offen sc1
    buffer_load_dwordx4 v[36:39], v29, s[24:27], s56 offen offset:1024 sc1
    s_add_u32 s56, s56, 8192
    buffer_load_dwordx4 v[40:43], v29, s[24:27], s56 offen sc1
    buffer_load_dwordx4 v[44:47], v29, s[24:27], s56 offen offset:1024 sc1
    s_add_u32 s56, s56, 8192
    buffer_load_dwordx4 v[48:51], v29, s[24:27], s56 offen sc1
    buffer_load_dwordx4 v[52:55], v29, s[24:27], s56 offen offset:1024 sc1
    s_add_u32 s56, s56, 8192
    s_mov_b32 s56, 0xbdd2d3e8
    s_mov_b32 s57, 0xbdd2d3e8
    v_mov_b32 v56, 0xc0135761
    v_mov_b32 v57, 0xc0135761
    s_mov_b32 s60, 1.0
    s_mov_b32 s61, 1.0
    s_mov_b32 s58, 0xffff0000
    s_waitcnt vmcnt(4)
.p2align 3
    v_lshlrev_b32 v80, 16, v32
    v_and_b32 v81, s58, v32
    v_lshlrev_b32 v82, 16, v33
    v_and_b32 v83, s58, v33
    v_lshlrev_b32 v84, 16, v34
    v_and_b32 v85, s58, v34
    v_lshlrev_b32 v86, 16, v35
    v_and_b32 v87, s58, v35
    v_lshlrev_b32 v88, 16, v36
    v_and_b32 v89, s58, v36
    v_lshlrev_b32 v90, 16, v37
    v_and_b32 v91, s58, v37
    v_lshlrev_b32 v92, 16, v38
    v_and_b32 v93, s58, v38
    v_lshlrev_b32 v94, 16, v39
    v_and_b32 v95, s58, v39
    v_pk_add_f32 v[64:65], v[64:65], v[80:81]
    v_pk_add_f32 v[66:67], v[66:67], v[82:83]
    v_pk_add_f32 v[68:69], v[68:69], v[84:85]
    v_pk_add_f32 v[70:71], v[70:71], v[86:87]
    v_pk_add_f32 v[72:73], v[72:73], v[88:89]
    v_pk_add_f32 v[74:75], v[74:75], v[90:91]
    v_pk_add_f32 v[76:77], v[76:77], v[92:93]
    v_pk_add_f32 v[78:79], v[78:79], v[94:95]
    s_waitcnt vmcnt(2)
.p2align 3
    v_lshlrev_b32 v80, 16, v40
    v_and_b32 v81, s58, v40
    v_lshlrev_b32 v82, 16, v41
    v_and_b32 v83, s58, v41
    v_lshlrev_b32 v84, 16, v42
    v_and_b32 v85, s58, v42
    v_lshlrev_b32 v86, 16, v43
    v_and_b32 v87, s58, v43
    v_lshlrev_b32 v88, 16, v44
    v_and_b32 v89, s58, v44
    v_lshlrev_b32 v90, 16, v45
    v_and_b32 v91, s58, v45
    v_lshlrev_b32 v92, 16, v46
    v_and_b32 v93, s58, v46
    v_lshlrev_b32 v94, 16, v47
    v_and_b32 v95, s58, v47
    v_pk_add_f32 v[64:65], v[64:65], v[80:81]
    v_pk_add_f32 v[66:67], v[66:67], v[82:83]
    v_pk_add_f32 v[68:69], v[68:69], v[84:85]
    v_pk_add_f32 v[70:71], v[70:71], v[86:87]
    v_pk_add_f32 v[72:73], v[72:73], v[88:89]
    v_pk_add_f32 v[74:75], v[74:75], v[90:91]
    v_pk_add_f32 v[76:77], v[76:77], v[92:93]
    v_pk_add_f32 v[78:79], v[78:79], v[94:95]
    s_waitcnt vmcnt(0)
.p2align 3
    v_lshlrev_b32 v80, 16, v48
    v_and_b32 v81, s58, v48
    v_lshlrev_b32 v82, 16, v49
    v_and_b32 v83, s58, v49
    v_lshlrev_b32 v84, 16, v50
    v_and_b32 v85, s58, v50
    v_lshlrev_b32 v86, 16, v51
    v_and_b32 v87, s58, v51
    v_lshlrev_b32 v88, 16, v52
    v_and_b32 v89, s58, v52
    v_lshlrev_b32 v90, 16, v53
    v_and_b32 v91, s58, v53
    v_lshlrev_b32 v92, 16, v54
    v_and_b32 v93, s58, v54
    v_lshlrev_b32 v94, 16, v55
    v_and_b32 v95, s58, v55
    v_pk_add_f32 v[64:65], v[64:65], v[80:81]
    v_pk_add_f32 v[66:67], v[66:67], v[82:83]
    v_pk_add_f32 v[68:69], v[68:69], v[84:85]
    v_pk_add_f32 v[70:71], v[70:71], v[86:87]
    v_pk_add_f32 v[72:73], v[72:73], v[88:89]
    v_pk_add_f32 v[74:75], v[74:75], v[90:91]
    v_pk_add_f32 v[76:77], v[76:77], v[92:93]
    v_pk_add_f32 v[78:79], v[78:79], v[94:95]
    v_pk_mul_f32 v[80:81], v[64:65], v[64:65]
    v_pk_mul_f32 v[82:83], v[66:67], v[66:67]
    v_pk_mul_f32 v[84:85], v[68:69], v[68:69]
    v_pk_mul_f32 v[86:87], v[70:71], v[70:71]
    v_pk_mul_f32 v[88:89], v[72:73], v[72:73]
    v_pk_mul_f32 v[90:91], v[74:75], v[74:75]
    v_pk_mul_f32 v[92:93], v[76:77], v[76:77]
    v_pk_mul_f32 v[94:95], v[78:79], v[78:79]
    v_pk_fma_f32 v[80:81], v[80:81], s[56:57], v[56:57]
    v_pk_fma_f32 v[82:83], v[82:83], s[56:57], v[56:57]
    v_pk_fma_f32 v[84:85], v[84:85], s[56:57], v[56:57]
    v_pk_fma_f32 v[86:87], v[86:87], s[56:57], v[56:57]
    v_pk_fma_f32 v[88:89], v[88:89], s[56:57], v[56:57]
    v_pk_fma_f32 v[90:91], v[90:91], s[56:57], v[56:57]
    v_pk_fma_f32 v[92:93], v[92:93], s[56:57], v[56:57]
    v_pk_fma_f32 v[94:95], v[94:95], s[56:57], v[56:57]
    v_pk_mul_f32 v[80:81], v[80:81], v[64:65]
    v_pk_mul_f32 v[82:83], v[82:83], v[66:67]
    v_pk_mul_f32 v[84:85], v[84:85], v[68:69]
    v_pk_mul_f32 v[86:87], v[86:87], v[70:71]
    v_pk_mul_f32 v[88:89], v[88:89], v[72:73]
    v_pk_mul_f32 v[90:91], v[90:91], v[74:75]
    v_pk_mul_f32 v[92:93], v[92:93], v[76:77]
    v_pk_mul_f32 v[94:95], v[94:95], v[78:79]
    v_exp_f32 v80, v80
    v_exp_f32 v81, v81
    v_exp_f32 v82, v82
    v_exp_f32 v83, v83
    v_exp_f32 v84, v84
    v_exp_f32 v85, v85
    v_exp_f32 v86, v86
    v_exp_f32 v87, v87
    v_exp_f32 v88, v88
    v_exp_f32 v89, v89
    v_exp_f32 v90, v90
    v_exp_f32 v91, v91
    v_exp_f32 v92, v92
    v_exp_f32 v93, v93
    v_exp_f32 v94, v94
    v_exp_f32 v95, v95
    v_pk_add_f32 v[80:81], v[80:81], s[60:61]
    v_pk_add_f32 v[82:83], v[82:83], s[60:61]
    v_pk_add_f32 v[84:85], v[84:85], s[60:61]
    v_pk_add_f32 v[86:87], v[86:87], s[60:61]
    v_pk_add_f32 v[88:89], v[88:89], s[60:61]
    v_pk_add_f32 v[90:91], v[90:91], s[60:61]
    v_pk_add_f32 v[92:93], v[92:93], s[60:61]
    v_pk_add_f32 v[94:95], v[94:95], s[60:61]
    v_rcp_f32 v80, v80
    v_rcp_f32 v81, v81
    v_rcp_f32 v82, v82
    v_rcp_f32 v83, v83
    v_rcp_f32 v84, v84
    v_rcp_f32 v85, v85
    v_rcp_f32 v86, v86
    v_rcp_f32 v87, v87
    v_rcp_f32 v88, v88
    v_rcp_f32 v89, v89
    v_rcp_f32 v90, v90
    v_rcp_f32 v91, v91
    v_rcp_f32 v92, v92
    v_rcp_f32 v93, v93
    v_rcp_f32 v94, v94
    v_rcp_f32 v95, v95
    v_pk_mul_f32 v[80:81], v[80:81], v[64:65]
    v_pk_mul_f32 v[82:83], v[82:83], v[66:67]
    v_pk_mul_f32 v[84:85], v[84:85], v[68:69]
    v_pk_mul_f32 v[86:87], v[86:87], v[70:71]
    v_pk_mul_f32 v[88:89], v[88:89], v[72:73]
    v_pk_mul_f32 v[90:91], v[90:91], v[74:75]
    v_pk_mul_f32 v[92:93], v[92:93], v[76:77]
    v_pk_mul_f32 v[94:95], v[94:95], v[78:79]
    v_cvt_pk_bf16_f32 v40, v80, v81
    v_cvt_pk_bf16_f32 v41, v82, v83
    v_cvt_pk_bf16_f32 v42, v84, v85
    v_cvt_pk_bf16_f32 v43, v86, v87
    v_cvt_pk_bf16_f32 v44, v88, v89
    v_cvt_pk_bf16_f32 v45, v90, v91
    v_cvt_pk_bf16_f32 v46, v92, v93
    v_cvt_pk_bf16_f32 v47, v94, v95
    s_mul_i32 s54, s51, 40960
    s_lshl_b32 s57, s52, 9
    s_add_u32 s54, s54, s57
    s_add_u32 s54, s54, 10485760
    buffer_store_dwordx4 v[40:43], v14, s[24:27], s54 offen sc1
    buffer_store_dwordx4 v[44:47], v14, s[24:27], s54 offen offset:256 sc1
    s_add_u32 m0, s49, 0
    s_nop 0
    buffer_load_dwordx4 v13, s[20:23], s64 offen offset:0 lds
    s_add_u32 s64, s64, 31744
    buffer_load_dwordx4 v13, s[20:23], s64 offen offset:1024 lds
    s_add_u32 s64, s64, 31744
    buffer_load_dwordx4 v13, s[20:23], s64 offen offset:2048 lds
    s_add_u32 s64, s64, 31744
    buffer_load_dwordx4 v13, s[20:23], s64 offen offset:3072 lds
    s_add_u32 s64, s64, 35840
    s_mul_i32 s54, s52, 410
    s_add_u32 s58, s54, 397
    s_lshr_b32 s54, s54, 10
    s_lshr_b32 s58, s58, 10
    s_cmp_eq_u32 s54, s58
    s_mov_b32 s58, 65535
    s_cmov_b32 s58, 255
    s_mov_b32 s59, 0
    s_mul_i32 s57, s101, 11
    s_lshr_b32 s57, s57, 5
    s_lshl_b32 s57, s57, 3
    s_add_u32 s54, s54, s57
    s_mul_i32 s54, s54, 512
    s_add_u32 s54, s54, 15286272
    v_mul_u32_u24 v32, 64, v0
    v_mov_b32 v31, 1
    s_mov_b64 exec, s[58:59]
    s_waitcnt vmcnt(4)
    buffer_atomic_add v31, v32, s[24:27], s54 offen sc1
    s_mov_b64 exec, -1
    s_branch gated_mix__mha_block__mixer_token_mlp__prompt_kernel_g1fin89
gated_mix__mha_block__mixer_token_mlp__prompt_kernel_g1skip88:
    s_barrier
    s_barrier
    s_barrier
    s_barrier
    s_barrier
    s_barrier
    s_barrier
    s_setprio 3
    s_mov_b32 s45, 800000
gated_mix__mha_block__mixer_token_mlp__prompt_kernel_spin99:
    ds_read_b32 v165, v164 offset:0
    s_waitcnt lgkmcnt(0)
    v_cmp_gt_u32 vcc, 6, v165
    s_cbranch_vccz gated_mix__mha_block__mixer_token_mlp__prompt_kernel_spind100
    s_sleep 8
    s_sub_u32 s45, s45, 1
    s_cbranch_scc0 gated_mix__mha_block__mixer_token_mlp__prompt_kernel_spin99
gated_mix__mha_block__mixer_token_mlp__prompt_kernel_spind100:
    s_add_u32 m0, s49, 0
    s_nop 0
    buffer_load_dwordx4 v13, s[20:23], s64 offen offset:0 lds
    s_add_u32 s64, s64, 31744
    buffer_load_dwordx4 v13, s[20:23], s64 offen offset:1024 lds
    s_add_u32 s64, s64, 31744
    buffer_load_dwordx4 v13, s[20:23], s64 offen offset:2048 lds
    s_add_u32 s64, s64, 31744
    buffer_load_dwordx4 v13, s[20:23], s64 offen offset:3072 lds
    s_add_u32 s64, s64, 35840
    s_waitcnt vmcnt(0)
gated_mix__mha_block__mixer_token_mlp__prompt_kernel_g1fin89:
    s_lshl_b32 s60, s44, 2
    s_add_u32 s60, s60, s48
    s_mul_i32 s61, s60, 6400
    v_min_u32 v30, 49, v0
    v_lshlrev_b32 v30, 7, v30
    buffer_load_dword v167, v30, s[12:15], s61 offen
    s_setprio 0
    s_add_u32 m0, s49, 4096
    s_nop 0
    buffer_load_dwordx4 v13, s[20:23], s64 offen offset:0 lds
    s_add_u32 s64, s64, 31744
    buffer_load_dwordx4 v13, s[20:23], s64 offen offset:1024 lds
    s_add_u32 s64, s64, 31744
    buffer_load_dwordx4 v13, s[20:23], s64 offen offset:2048 lds
    s_add_u32 s64, s64, 31744
    buffer_load_dwordx4 v13, s[20:23], s64 offen offset:3072 lds
    s_add_u32 s64, s64, 35840
    s_waitcnt vmcnt(0)
    s_add_u32 m0, s49, 8192
    s_nop 0
    buffer_load_dwordx4 v13, s[20:23], s64 offen offset:0 lds
    s_add_u32 s64, s64, 31744
    buffer_load_dwordx4 v13, s[20:23], s64 offen offset:1024 lds
    s_add_u32 s64, s64, 31744
    buffer_load_dwordx4 v13, s[20:23], s64 offen offset:2048 lds
    s_add_u32 s64, s64, 31744
    buffer_load_dwordx4 v13, s[20:23], s64 offen offset:3072 lds
    s_add_u32 s64, s64, 35840
    s_setprio 3
    s_mul_i32 s55, s63, 80
    s_lshr_b32 s54, s55, 7
    s_add_u32 s55, s55, 79
    s_lshr_b32 s55, s55, 7
    s_cmp_eq_u32 s54, s55
    s_cselect_b32 s55, 12, 24
    s_mov_b32 s55, 36
    s_lshl_b32 s54, s48, 3
    s_add_u32 s54, s54, s63
    s_lshl_b32 s54, s54, 3
    s_and_b32 s57, s43, 7
    s_add_u32 s54, s54, s57
    s_mul_i32 s54, s54, 64
    s_add_u32 s54, s54, 15286272
    s_mul_i32 s57, s62, 32
    s_add_u32 s57, s57, 15285248
    v_and_b32 v25, 7, v0
    v_mul_u32_u24 v25, 4, v25
    buffer_load_dword v28, v25, s[24:27], s57 offen offset:0 sc1
    s_mov_b32 s45, 200000
gated_mix__mha_block__mixer_token_mlp__prompt_kernel_apoll101:
    s_mov_b64 exec, 1
    v_mov_b32 v26, 0
    v_mov_b32 v27, 0
    buffer_atomic_add v27, v26, s[24:27], s54 offen sc0 sc1
gated_mix__mha_block__mixer_token_mlp__prompt_kernel_apollc103:
    s_waitcnt vmcnt(0)
    v_cmp_gt_u32 vcc, s55, v27
    s_cbranch_vccz gated_mix__mha_block__mixer_token_mlp__prompt_kernel_apolld102
    s_sleep 4
    s_sub_u32 s45, s45, 1
    s_cbranch_scc0 gated_mix__mha_block__mixer_token_mlp__prompt_kernel_apoll101
gated_mix__mha_block__mixer_token_mlp__prompt_kernel_apolld102:
    s_mov_b64 exec, -1
    s_mov_b32 s45, 200000
    s_waitcnt vmcnt(0)
    s_branch gated_mix__mha_block__mixer_token_mlp__prompt_kernel_pollc106
gated_mix__mha_block__mixer_token_mlp__prompt_kernel_poll104:
    buffer_load_dword v28, v25, s[24:27], s57 offen offset:0 sc1
    s_waitcnt vmcnt(0)
gated_mix__mha_block__mixer_token_mlp__prompt_kernel_pollc106:
    v_cmp_eq_u32 vcc, 0, v28
    s_cbranch_vccz gated_mix__mha_block__mixer_token_mlp__prompt_kernel_polld105
    s_sleep 4
    s_sub_u32 s45, s45, 1
    s_cbranch_scc0 gated_mix__mha_block__mixer_token_mlp__prompt_kernel_poll104
gated_mix__mha_block__mixer_token_mlp__prompt_kernel_polld105:
    s_lshl_b32 s54, s66, 2
    s_add_u32 s54, s54, 15204352
    v_and_b32 v22, 15, v0
    v_lshlrev_b32 v22, 2, v22
    s_setprio 0
    buffer_load_dword v22, v22, s[24:27], s54 offen sc1
    buffer_load_dwordx4 v[24:27], v14, s[24:27], s65 offen offset:0 sc1
    buffer_load_dwordx4 v[28:31], v14, s[24:27], s65 offen offset:256 sc1
    buffer_load_dwordx4 v[32:35], v14, s[24:27], s65 offen offset:512 sc1
    buffer_load_dwordx4 v[36:39], v14, s[24:27], s65 offen offset:768 sc1
    buffer_load_dwordx4 v[40:43], v14, s[24:27], s65 offen offset:1024 sc1
    s_add_u32 s65, s65, 40960
    buffer_load_dwordx4 v[44:47], v14, s[24:27], s65 offen offset:0 sc1
    buffer_load_dwordx4 v[48:51], v14, s[24:27], s65 offen offset:256 sc1
    buffer_load_dwordx4 v[52:55], v14, s[24:27], s65 offen offset:512 sc1
    buffer_load_dwordx4 v[56:59], v14, s[24:27], s65 offen offset:768 sc1
    buffer_load_dwordx4 v[60:63], v14, s[24:27], s65 offen offset:1024 sc1
    s_add_u32 s65, s65, 40960
    s_waitcnt vmcnt(10)
    ds_read_b64_tr_b16 v[144:145], v15 offset:0
    ds_read_b64_tr_b16 v[146:147], v15 offset:2048
    ds_read_b64_tr_b16 v[148:149], v16 offset:0
    ds_read_b64_tr_b16 v[150:151], v16 offset:2048
    ds_read_b64_tr_b16 v[152:153], v17 offset:0
    ds_read_b64_tr_b16 v[154:155], v17 offset:2048
    ds_read_b64_tr_b16 v[156:157], v18 offset:0
    ds_read_b64_tr_b16 v[158:159], v18 offset:2048
    s_mul_i32 s56, s48, 204800
    s_mul_i32 s54, s63, 160
    s_add_u32 s56, s56, s54
    s_waitcnt vmcnt(5)
    s_waitcnt lgkmcnt(6)
    v_mfma_f32_16x16x32_bf16 v[64:67], v[24:27], v[144:147], 0
    v_mfma_f32_16x16x32_bf16 v[68:71], v[28:31], v[144:147], 0
    v_mfma_f32_16x16x32_bf16 v[72:75], v[32:35], v[144:147], 0
    v_mfma_f32_16x16x32_bf16 v[76:79], v[36:39], v[144:147], 0
    v_mfma_f32_16x16x32_bf16 v[80:83], v[40:43], v[144:147], 0
    ds_read_b64_tr_b16 v[144:145], v15 offset:4096
    ds_read_b64_tr_b16 v[146:147], v15 offset:6144
    s_waitcnt lgkmcnt(6)
    v_mfma_f32_16x16x32_bf16 v[100:103], v[40:43], v[148:151], 0
    v_mfma_f32_16x16x32_bf16 v[96:99], v[36:39], v[148:151], 0
    v_mfma_f32_16x16x32_bf16 v[92:95], v[32:35], v[148:151], 0
    v_mfma_f32_16x16x32_bf16 v[88:91], v[28:31], v[148:151], 0
    v_mfma_f32_16x16x32_bf16 v[84:87], v[24:27], v[148:151], 0
    ds_read_b64_tr_b16 v[148:149], v16 offset:4096
    ds_read_b64_tr_b16 v[150:151], v16 offset:6144
    s_waitcnt lgkmcnt(6)
    v_mfma_f32_16x16x32_bf16 v[104:107], v[24:27], v[152:155], 0
    s_add_u32 m0, s49, 18432
    s_add_u32 s57, s56, 122880
    buffer_load_dwordx4 v4, s[12:15], s57 offen lds
    v_mfma_f32_16x16x32_bf16 v[108:111], v[28:31], v[152:155], 0
    v_mfma_f32_16x16x32_bf16 v[112:115], v[32:35], v[152:155], 0
    v_mfma_f32_16x16x32_bf16 v[116:119], v[36:39], v[152:155], 0
    v_mfma_f32_16x16x32_bf16 v[120:123], v[40:43], v[152:155], 0
    ds_read_b64_tr_b16 v[152:153], v17 offset:4096
    ds_read_b64_tr_b16 v[154:155], v17 offset:6144
    s_waitcnt lgkmcnt(6)
    v_mfma_f32_16x16x32_bf16 v[140:143], v[40:43], v[156:159], 0
    s_add_u32 m0, s49, 0
    s_nop 0
    buffer_load_dwordx4 v13, s[20:23], s64 offen offset:0 lds
    s_add_u32 s64, s64, 31744
    v_mfma_f32_16x16x32_bf16 v[136:139], v[36:39], v[156:159], 0
    buffer_load_dwordx4 v13, s[20:23], s64 offen offset:1024 lds
    s_add_u32 s64, s64, 31744
    v_mfma_f32_16x16x32_bf16 v[132:135], v[32:35], v[156:159], 0
    buffer_load_dwordx4 v13, s[20:23], s64 offen offset:2048 lds
    s_add_u32 s64, s64, 31744
    v_mfma_f32_16x16x32_bf16 v[128:131], v[28:31], v[156:159], 0
    buffer_load_dwordx4 v13, s[20:23], s64 offen offset:3072 lds
    s_add_u32 s64, s64, 35840
    v_mfma_f32_16x16x32_bf16 v[124:127], v[24:27], v[156:159], 0
    ds_read_b64_tr_b16 v[156:157], v18 offset:4096
    ds_read_b64_tr_b16 v[158:159], v18 offset:6144
    s_waitcnt vmcnt(5)
    s_waitcnt lgkmcnt(6)
    v_mfma_f32_16x16x32_bf16 v[64:67], v[44:47], v[144:147], v[64:67]
    buffer_load_dwordx4 v[24:27], v14, s[24:27], s65 offen offset:0 sc1
    v_mfma_f32_16x16x32_bf16 v[68:71], v[48:51], v[144:147], v[68:71]
    buffer_load_dwordx4 v[28:31], v14, s[24:27], s65 offen offset:256 sc1
    v_mfma_f32_16x16x32_bf16 v[72:75], v[52:55], v[144:147], v[72:75]
    buffer_load_dwordx4 v[32:35], v14, s[24:27], s65 offen offset:512 sc1
    v_mfma_f32_16x16x32_bf16 v[76:79], v[56:59], v[144:147], v[76:79]
    buffer_load_dwordx4 v[36:39], v14, s[24:27], s65 offen offset:768 sc1
    v_mfma_f32_16x16x32_bf16 v[80:83], v[60:63], v[144:147], v[80:83]
    buffer_load_dwordx4 v[40:43], v14, s[24:27], s65 offen offset:1024 sc1
    s_add_u32 s65, s65, 40960
    ds_read_b64_tr_b16 v[144:145], v15 offset:8192
    ds_read_b64_tr_b16 v[146:147], v15 offset:10240
    s_waitcnt lgkmcnt(6)
    v_mfma_f32_16x16x32_bf16 v[100:103], v[60:63], v[148:151], v[100:103]
    v_mfma_f32_16x16x32_bf16 v[96:99], v[56:59], v[148:151], v[96:99]
    v_mfma_f32_16x16x32_bf16 v[92:95], v[52:55], v[148:151], v[92:95]
    v_mfma_f32_16x16x32_bf16 v[88:91], v[48:51], v[148:151], v[88:91]
    v_mfma_f32_16x16x32_bf16 v[84:87], v[44:47], v[148:151], v[84:87]
    ds_read_b64_tr_b16 v[148:149], v16 offset:8192
    ds_read_b64_tr_b16 v[150:151], v16 offset:10240
    s_waitcnt lgkmcnt(6)
    v_mfma_f32_16x16x32_bf16 v[104:107], v[44:47], v[152:155], v[104:107]
    s_add_u32 m0, s49, 19456
    s_add_u32 s57, s56, 122880
    buffer_load_dwordx4 v5, s[12:15], s57 offen lds
    v_mfma_f32_16x16x32_bf16 v[108:111], v[48:51], v[152:155], v[108:111]
    v_mfma_f32_16x16x32_bf16 v[112:115], v[52:55], v[152:155], v[112:115]
    v_mfma_f32_16x16x32_bf16 v[116:119], v[56:59], v[152:155], v[116:119]
    v_mfma_f32_16x16x32_bf16 v[120:123], v[60:63], v[152:155], v[120:123]
    ds_read_b64_tr_b16 v[152:153], v17 offset:8192
    ds_read_b64_tr_b16 v[154:155], v17 offset:10240
    s_waitcnt lgkmcnt(6)
    v_mfma_f32_16x16x32_bf16 v[140:143], v[60:63], v[156:159], v[140:143]
    s_add_u32 m0, s49, 4096
    s_nop 0
    buffer_load_dwordx4 v13, s[20:23], s64 offen offset:0 lds
    s_add_u32 s64, s64, 31744
    v_mfma_f32_16x16x32_bf16 v[136:139], v[56:59], v[156:159], v[136:139]
    buffer_load_dwordx4 v13, s[20:23], s64 offen offset:1024 lds
    s_add_u32 s64, s64, 31744
    v_mfma_f32_16x16x32_bf16 v[132:135], v[52:55], v[156:159], v[132:135]
    buffer_load_dwordx4 v13, s[20:23], s64 offen offset:2048 lds
    s_add_u32 s64, s64, 31744
    v_mfma_f32_16x16x32_bf16 v[128:131], v[48:51], v[156:159], v[128:131]
    buffer_load_dwordx4 v13, s[20:23], s64 offen offset:3072 lds
    s_add_u32 s64, s64, 35840
    v_mfma_f32_16x16x32_bf16 v[124:127], v[44:47], v[156:159], v[124:127]
    ds_read_b64_tr_b16 v[156:157], v18 offset:8192
    ds_read_b64_tr_b16 v[158:159], v18 offset:10240
    s_waitcnt vmcnt(5)
    s_waitcnt lgkmcnt(6)
    v_mfma_f32_16x16x32_bf16 v[64:67], v[24:27], v[144:147], v[64:67]
    buffer_load_dwordx4 v[44:47], v14, s[24:27], s65 offen offset:0 sc1
    v_mfma_f32_16x16x32_bf16 v[68:71], v[28:31], v[144:147], v[68:71]
    buffer_load_dwordx4 v[48:51], v14, s[24:27], s65 offen offset:256 sc1
    v_mfma_f32_16x16x32_bf16 v[72:75], v[32:35], v[144:147], v[72:75]
    buffer_load_dwordx4 v[52:55], v14, s[24:27], s65 offen offset:512 sc1
    v_mfma_f32_16x16x32_bf16 v[76:79], v[36:39], v[144:147], v[76:79]
    buffer_load_dwordx4 v[56:59], v14, s[24:27], s65 offen offset:768 sc1
    v_mfma_f32_16x16x32_bf16 v[80:83], v[40:43], v[144:147], v[80:83]
    buffer_load_dwordx4 v[60:63], v14, s[24:27], s65 offen offset:1024 sc1
    s_add_u32 s65, s65, 40960
    ds_read_b64_tr_b16 v[144:145], v15 offset:0
    ds_read_b64_tr_b16 v[146:147], v15 offset:2048
    s_waitcnt lgkmcnt(6)
    v_mfma_f32_16x16x32_bf16 v[100:103], v[40:43], v[148:151], v[100:103]
    v_mfma_f32_16x16x32_bf16 v[96:99], v[36:39], v[148:151], v[96:99]
    v_mfma_f32_16x16x32_bf16 v[92:95], v[32:35], v[148:151], v[92:95]
    v_mfma_f32_16x16x32_bf16 v[88:91], v[28:31], v[148:151], v[88:91]
    v_mfma_f32_16x16x32_bf16 v[84:87], v[24:27], v[148:151], v[84:87]
    ds_read_b64_tr_b16 v[148:149], v16 offset:0
    ds_read_b64_tr_b16 v[150:151], v16 offset:2048
    s_waitcnt lgkmcnt(6)
    v_mfma_f32_16x16x32_bf16 v[104:107], v[24:27], v[152:155], v[104:107]
    s_add_u32 m0, s49, 20480
    s_add_u32 s57, s56, 163840
    buffer_load_dwordx4 v1, s[12:15], s57 offen lds
    v_mfma_f32_16x16x32_bf16 v[108:111], v[28:31], v[152:155], v[108:111]
    v_mfma_f32_16x16x32_bf16 v[112:115], v[32:35], v[152:155], v[112:115]
    v_mfma_f32_16x16x32_bf16 v[116:119], v[36:39], v[152:155], v[116:119]
    v_mfma_f32_16x16x32_bf16 v[120:123], v[40:43], v[152:155], v[120:123]
    ds_read_b64_tr_b16 v[152:153], v17 offset:0
    ds_read_b64_tr_b16 v[154:155], v17 offset:2048
    s_waitcnt lgkmcnt(6)
    v_mfma_f32_16x16x32_bf16 v[140:143], v[40:43], v[156:159], v[140:143]
    s_add_u32 m0, s49, 8192
    s_nop 0
    buffer_load_dwordx4 v13, s[20:23], s64 offen offset:0 lds
    s_add_u32 s64, s64, 31744
    v_mfma_f32_16x16x32_bf16 v[136:139], v[36:39], v[156:159], v[136:139]
    buffer_load_dwordx4 v13, s[20:23], s64 offen offset:1024 lds
    s_add_u32 s64, s64, 31744
    v_mfma_f32_16x16x32_bf16 v[132:135], v[32:35], v[156:159], v[132:135]
    buffer_load_dwordx4 v13, s[20:23], s64 offen offset:2048 lds
    s_add_u32 s64, s64, 31744
    v_mfma_f32_16x16x32_bf16 v[128:131], v[28:31], v[156:159], v[128:131]
    buffer_load_dwordx4 v13, s[20:23], s64 offen offset:3072 lds
    s_add_u32 s64, s64, 35840
    v_mfma_f32_16x16x32_bf16 v[124:127], v[24:27], v[156:159], v[124:127]
    ds_read_b64_tr_b16 v[156:157], v18 offset:0
    ds_read_b64_tr_b16 v[158:159], v18 offset:2048
    s_waitcnt vmcnt(5)
    s_waitcnt lgkmcnt(6)
    v_mfma_f32_16x16x32_bf16 v[64:67], v[44:47], v[144:147], v[64:67]
    buffer_load_dwordx4 v[24:27], v14, s[24:27], s65 offen offset:0 sc1
    v_mfma_f32_16x16x32_bf16 v[68:71], v[48:51], v[144:147], v[68:71]
    buffer_load_dwordx4 v[28:31], v14, s[24:27], s65 offen offset:256 sc1
    v_mfma_f32_16x16x32_bf16 v[72:75], v[52:55], v[144:147], v[72:75]
    buffer_load_dwordx4 v[32:35], v14, s[24:27], s65 offen offset:512 sc1
    v_mfma_f32_16x16x32_bf16 v[76:79], v[56:59], v[144:147], v[76:79]
    buffer_load_dwordx4 v[36:39], v14, s[24:27], s65 offen offset:768 sc1
    v_mfma_f32_16x16x32_bf16 v[80:83], v[60:63], v[144:147], v[80:83]
    buffer_load_dwordx4 v[40:43], v14, s[24:27], s65 offen offset:1024 sc1
    s_add_u32 s65, s65, 40960
    ds_read_b64_tr_b16 v[144:145], v15 offset:4096
    ds_read_b64_tr_b16 v[146:147], v15 offset:6144
    s_waitcnt lgkmcnt(6)
    v_mfma_f32_16x16x32_bf16 v[100:103], v[60:63], v[148:151], v[100:103]
    v_mfma_f32_16x16x32_bf16 v[96:99], v[56:59], v[148:151], v[96:99]
    v_mfma_f32_16x16x32_bf16 v[92:95], v[52:55], v[148:151], v[92:95]
    v_mfma_f32_16x16x32_bf16 v[88:91], v[48:51], v[148:151], v[88:91]
    v_mfma_f32_16x16x32_bf16 v[84:87], v[44:47], v[148:151], v[84:87]
    ds_read_b64_tr_b16 v[148:149], v16 offset:4096
    ds_read_b64_tr_b16 v[150:151], v16 offset:6144
    s_waitcnt lgkmcnt(6)
    v_mfma_f32_16x16x32_bf16 v[104:107], v[44:47], v[152:155], v[104:107]
    s_add_u32 m0, s49, 21504
    s_add_u32 s57, s56, 163840
    buffer_load_dwordx4 v2, s[12:15], s57 offen lds
    v_mfma_f32_16x16x32_bf16 v[108:111], v[48:51], v[152:155], v[108:111]
    v_mfma_f32_16x16x32_bf16 v[112:115], v[52:55], v[152:155], v[112:115]
    v_mfma_f32_16x16x32_bf16 v[116:119], v[56:59], v[152:155], v[116:119]
    v_mfma_f32_16x16x32_bf16 v[120:123], v[60:63], v[152:155], v[120:123]
    ds_read_b64_tr_b16 v[152:153], v17 offset:4096
    ds_read_b64_tr_b16 v[154:155], v17 offset:6144
    s_waitcnt lgkmcnt(6)
    v_mfma_f32_16x16x32_bf16 v[140:143], v[60:63], v[156:159], v[140:143]
    s_add_u32 m0, s49, 0
    s_nop 0
    buffer_load_dwordx4 v13, s[20:23], s64 offen offset:0 lds
    s_add_u32 s64, s64, 31744
    v_mfma_f32_16x16x32_bf16 v[136:139], v[56:59], v[156:159], v[136:139]
    buffer_load_dwordx4 v13, s[20:23], s64 offen offset:1024 lds
    s_add_u32 s64, s64, 31744
    v_mfma_f32_16x16x32_bf16 v[132:135], v[52:55], v[156:159], v[132:135]
    buffer_load_dwordx4 v13, s[20:23], s64 offen offset:2048 lds
    s_add_u32 s64, s64, 31744
    v_mfma_f32_16x16x32_bf16 v[128:131], v[48:51], v[156:159], v[128:131]
    buffer_load_dwordx4 v13, s[20:23], s64 offen offset:3072 lds
    s_add_u32 s64, s64, 35840
    v_mfma_f32_16x16x32_bf16 v[124:127], v[44:47], v[156:159], v[124:127]
    ds_read_b64_tr_b16 v[156:157], v18 offset:4096
    ds_read_b64_tr_b16 v[158:159], v18 offset:6144
    s_waitcnt vmcnt(5)
    s_waitcnt lgkmcnt(6)
    v_mfma_f32_16x16x32_bf16 v[64:67], v[24:27], v[144:147], v[64:67]
    buffer_load_dwordx4 v[44:47], v14, s[24:27], s65 offen offset:0 sc1
    v_mfma_f32_16x16x32_bf16 v[68:71], v[28:31], v[144:147], v[68:71]
    buffer_load_dwordx4 v[48:51], v14, s[24:27], s65 offen offset:256 sc1
    v_mfma_f32_16x16x32_bf16 v[72:75], v[32:35], v[144:147], v[72:75]
    buffer_load_dwordx4 v[52:55], v14, s[24:27], s65 offen offset:512 sc1
    v_mfma_f32_16x16x32_bf16 v[76:79], v[36:39], v[144:147], v[76:79]
    buffer_load_dwordx4 v[56:59], v14, s[24:27], s65 offen offset:768 sc1
    v_mfma_f32_16x16x32_bf16 v[80:83], v[40:43], v[144:147], v[80:83]
    buffer_load_dwordx4 v[60:63], v14, s[24:27], s65 offen offset:1024 sc1
    s_add_u32 s65, s65, 40960
    ds_read_b64_tr_b16 v[144:145], v15 offset:8192
    ds_read_b64_tr_b16 v[146:147], v15 offset:10240
    s_waitcnt lgkmcnt(6)
    v_mfma_f32_16x16x32_bf16 v[100:103], v[40:43], v[148:151], v[100:103]
    v_mfma_f32_16x16x32_bf16 v[96:99], v[36:39], v[148:151], v[96:99]
    v_mfma_f32_16x16x32_bf16 v[92:95], v[32:35], v[148:151], v[92:95]
    v_mfma_f32_16x16x32_bf16 v[88:91], v[28:31], v[148:151], v[88:91]
    v_mfma_f32_16x16x32_bf16 v[84:87], v[24:27], v[148:151], v[84:87]
    ds_read_b64_tr_b16 v[148:149], v16 offset:8192
    ds_read_b64_tr_b16 v[150:151], v16 offset:10240
    s_waitcnt lgkmcnt(6)
    v_mfma_f32_16x16x32_bf16 v[104:107], v[24:27], v[152:155], v[104:107]
    s_add_u32 m0, s49, 22528
    s_add_u32 s57, s56, 163840
    buffer_load_dwordx4 v3, s[12:15], s57 offen lds
    v_mfma_f32_16x16x32_bf16 v[108:111], v[28:31], v[152:155], v[108:111]
    v_mfma_f32_16x16x32_bf16 v[112:115], v[32:35], v[152:155], v[112:115]
    v_mfma_f32_16x16x32_bf16 v[116:119], v[36:39], v[152:155], v[116:119]
    v_mfma_f32_16x16x32_bf16 v[120:123], v[40:43], v[152:155], v[120:123]
    ds_read_b64_tr_b16 v[152:153], v17 offset:8192
    ds_read_b64_tr_b16 v[154:155], v17 offset:10240
    s_waitcnt lgkmcnt(6)
    v_mfma_f32_16x16x32_bf16 v[140:143], v[40:43], v[156:159], v[140:143]
    s_add_u32 m0, s49, 4096
    s_nop 0
    buffer_load_dwordx4 v13, s[20:23], s64 offen offset:0 lds
    s_add_u32 s64, s64, 31744
    v_mfma_f32_16x16x32_bf16 v[136:139], v[36:39], v[156:159], v[136:139]
    buffer_load_dwordx4 v13, s[20:23], s64 offen offset:1024 lds
    s_add_u32 s64, s64, 31744
    v_mfma_f32_16x16x32_bf16 v[132:135], v[32:35], v[156:159], v[132:135]
    buffer_load_dwordx4 v13, s[20:23], s64 offen offset:2048 lds
    s_add_u32 s64, s64, 31744
    v_mfma_f32_16x16x32_bf16 v[128:131], v[28:31], v[156:159], v[128:131]
    buffer_load_dwordx4 v13, s[20:23], s64 offen offset:3072 lds
    s_add_u32 s64, s64, 35840
    v_mfma_f32_16x16x32_bf16 v[124:127], v[24:27], v[156:159], v[124:127]
    ds_read_b64_tr_b16 v[156:157], v18 offset:8192
    ds_read_b64_tr_b16 v[158:159], v18 offset:10240
    s_waitcnt vmcnt(5)
    s_waitcnt lgkmcnt(6)
    v_mfma_f32_16x16x32_bf16 v[64:67], v[44:47], v[144:147], v[64:67]
    buffer_load_dwordx4 v[24:27], v14, s[24:27], s65 offen offset:0 sc1
    v_mfma_f32_16x16x32_bf16 v[68:71], v[48:51], v[144:147], v[68:71]
    buffer_load_dwordx4 v[28:31], v14, s[24:27], s65 offen offset:256 sc1
    v_mfma_f32_16x16x32_bf16 v[72:75], v[52:55], v[144:147], v[72:75]
    buffer_load_dwordx4 v[32:35], v14, s[24:27], s65 offen offset:512 sc1
    v_mfma_f32_16x16x32_bf16 v[76:79], v[56:59], v[144:147], v[76:79]
    buffer_load_dwordx4 v[36:39], v14, s[24:27], s65 offen offset:768 sc1
    v_mfma_f32_16x16x32_bf16 v[80:83], v[60:63], v[144:147], v[80:83]
    buffer_load_dwordx4 v[40:43], v14, s[24:27], s65 offen offset:1024 sc1
    s_add_u32 s65, s65, 40960
    ds_read_b64_tr_b16 v[144:145], v15 offset:0
    ds_read_b64_tr_b16 v[146:147], v15 offset:2048
    s_waitcnt lgkmcnt(6)
    v_mfma_f32_16x16x32_bf16 v[100:103], v[60:63], v[148:151], v[100:103]
    v_mfma_f32_16x16x32_bf16 v[96:99], v[56:59], v[148:151], v[96:99]
    v_mfma_f32_16x16x32_bf16 v[92:95], v[52:55], v[148:151], v[92:95]
    v_mfma_f32_16x16x32_bf16 v[88:91], v[48:51], v[148:151], v[88:91]
    v_mfma_f32_16x16x32_bf16 v[84:87], v[44:47], v[148:151], v[84:87]
    ds_read_b64_tr_b16 v[148:149], v16 offset:0
    ds_read_b64_tr_b16 v[150:151], v16 offset:2048
    s_waitcnt lgkmcnt(6)
    v_mfma_f32_16x16x32_bf16 v[104:107], v[44:47], v[152:155], v[104:107]
    s_add_u32 m0, s49, 23552
    s_add_u32 s57, s56, 163840
    buffer_load_dwordx4 v4, s[12:15], s57 offen lds
    v_mfma_f32_16x16x32_bf16 v[108:111], v[48:51], v[152:155], v[108:111]
    v_mfma_f32_16x16x32_bf16 v[112:115], v[52:55], v[152:155], v[112:115]
    v_mfma_f32_16x16x32_bf16 v[116:119], v[56:59], v[152:155], v[116:119]
    v_mfma_f32_16x16x32_bf16 v[120:123], v[60:63], v[152:155], v[120:123]
    ds_read_b64_tr_b16 v[152:153], v17 offset:0
    ds_read_b64_tr_b16 v[154:155], v17 offset:2048
    s_waitcnt lgkmcnt(6)
    v_mfma_f32_16x16x32_bf16 v[140:143], v[60:63], v[156:159], v[140:143]
    s_add_u32 m0, s49, 8192
    s_nop 0
    buffer_load_dwordx4 v13, s[20:23], s64 offen offset:0 lds
    s_add_u32 s64, s64, 31744
    v_mfma_f32_16x16x32_bf16 v[136:139], v[56:59], v[156:159], v[136:139]
    buffer_load_dwordx4 v13, s[20:23], s64 offen offset:1024 lds
    s_add_u32 s64, s64, 31744
    v_mfma_f32_16x16x32_bf16 v[132:135], v[52:55], v[156:159], v[132:135]
    buffer_load_dwordx4 v13, s[20:23], s64 offen offset:2048 lds
    s_add_u32 s64, s64, 31744
    v_mfma_f32_16x16x32_bf16 v[128:131], v[48:51], v[156:159], v[128:131]
    buffer_load_dwordx4 v13, s[20:23], s64 offen offset:3072 lds
    s_add_u32 s64, s64, 35840
    v_mfma_f32_16x16x32_bf16 v[124:127], v[44:47], v[156:159], v[124:127]
    ds_read_b64_tr_b16 v[156:157], v18 offset:0
    ds_read_b64_tr_b16 v[158:159], v18 offset:2048
    s_waitcnt vmcnt(5)
    s_waitcnt lgkmcnt(6)
    v_mfma_f32_16x16x32_bf16 v[64:67], v[24:27], v[144:147], v[64:67]
    buffer_load_dwordx4 v[44:47], v14, s[24:27], s65 offen offset:0 sc1
    v_mfma_f32_16x16x32_bf16 v[68:71], v[28:31], v[144:147], v[68:71]
    buffer_load_dwordx4 v[48:51], v14, s[24:27], s65 offen offset:256 sc1
    v_mfma_f32_16x16x32_bf16 v[72:75], v[32:35], v[144:147], v[72:75]
    buffer_load_dwordx4 v[52:55], v14, s[24:27], s65 offen offset:512 sc1
    v_mfma_f32_16x16x32_bf16 v[76:79], v[36:39], v[144:147], v[76:79]
    buffer_load_dwordx4 v[56:59], v14, s[24:27], s65 offen offset:768 sc1
    v_mfma_f32_16x16x32_bf16 v[80:83], v[40:43], v[144:147], v[80:83]
    buffer_load_dwordx4 v[60:63], v14, s[24:27], s65 offen offset:1024 sc1
    s_add_u32 s65, s65, 40960
    ds_read_b64_tr_b16 v[144:145], v15 offset:4096
    ds_read_b64_tr_b16 v[146:147], v15 offset:6144
    s_waitcnt lgkmcnt(6)
    v_mfma_f32_16x16x32_bf16 v[100:103], v[40:43], v[148:151], v[100:103]
    v_mfma_f32_16x16x32_bf16 v[96:99], v[36:39], v[148:151], v[96:99]
    v_mfma_f32_16x16x32_bf16 v[92:95], v[32:35], v[148:151], v[92:95]
    v_mfma_f32_16x16x32_bf16 v[88:91], v[28:31], v[148:151], v[88:91]
    v_mfma_f32_16x16x32_bf16 v[84:87], v[24:27], v[148:151], v[84:87]
    ds_read_b64_tr_b16 v[148:149], v16 offset:4096
    ds_read_b64_tr_b16 v[150:151], v16 offset:6144
    s_waitcnt lgkmcnt(6)
    v_mfma_f32_16x16x32_bf16 v[104:107], v[24:27], v[152:155], v[104:107]
    s_add_u32 m0, s49, 24576
    s_add_u32 s57, s56, 163840
    buffer_load_dwordx4 v5, s[12:15], s57 offen lds
    v_mfma_f32_16x16x32_bf16 v[108:111], v[28:31], v[152:155], v[108:111]
    v_mfma_f32_16x16x32_bf16 v[112:115], v[32:35], v[152:155], v[112:115]
    v_mfma_f32_16x16x32_bf16 v[116:119], v[36:39], v[152:155], v[116:119]
    v_mfma_f32_16x16x32_bf16 v[120:123], v[40:43], v[152:155], v[120:123]
    ds_read_b64_tr_b16 v[152:153], v17 offset:4096
    ds_read_b64_tr_b16 v[154:155], v17 offset:6144
    s_waitcnt lgkmcnt(6)
    v_mfma_f32_16x16x32_bf16 v[140:143], v[40:43], v[156:159], v[140:143]
    s_add_u32 m0, s49, 0
    s_nop 0
    buffer_load_dwordx4 v13, s[20:23], s64 offen offset:0 lds
    s_add_u32 s64, s64, 31744
    v_mfma_f32_16x16x32_bf16 v[136:139], v[36:39], v[156:159], v[136:139]
    buffer_load_dwordx4 v13, s[20:23], s64 offen offset:1024 lds
    s_add_u32 s64, s64, 31744
    v_mfma_f32_16x16x32_bf16 v[132:135], v[32:35], v[156:159], v[132:135]
    buffer_load_dwordx4 v13, s[20:23], s64 offen offset:2048 lds
    s_add_u32 s64, s64, 31744
    v_mfma_f32_16x16x32_bf16 v[128:131], v[28:31], v[156:159], v[128:131]
    buffer_load_dwordx4 v13, s[20:23], s64 offen offset:3072 lds
    s_add_u32 s64, s64, 35840
    v_mfma_f32_16x16x32_bf16 v[124:127], v[24:27], v[156:159], v[124:127]
    ds_read_b64_tr_b16 v[156:157], v18 offset:4096
    ds_read_b64_tr_b16 v[158:159], v18 offset:6144
    s_waitcnt vmcnt(5)
    s_waitcnt lgkmcnt(6)
    v_mfma_f32_16x16x32_bf16 v[64:67], v[44:47], v[144:147], v[64:67]
    buffer_load_dwordx4 v[24:27], v14, s[24:27], s65 offen offset:0 sc1
    v_mfma_f32_16x16x32_bf16 v[68:71], v[48:51], v[144:147], v[68:71]
    buffer_load_dwordx4 v[28:31], v14, s[24:27], s65 offen offset:256 sc1
    v_mfma_f32_16x16x32_bf16 v[72:75], v[52:55], v[144:147], v[72:75]
    buffer_load_dwordx4 v[32:35], v14, s[24:27], s65 offen offset:512 sc1
    v_mfma_f32_16x16x32_bf16 v[76:79], v[56:59], v[144:147], v[76:79]
    buffer_load_dwordx4 v[36:39], v14, s[24:27], s65 offen offset:768 sc1
    v_mfma_f32_16x16x32_bf16 v[80:83], v[60:63], v[144:147], v[80:83]
    buffer_load_dwordx4 v[40:43], v14, s[24:27], s65 offen offset:1024 sc1
    s_add_u32 s65, s65, 40960
    ds_read_b64_tr_b16 v[144:145], v15 offset:8192
    ds_read_b64_tr_b16 v[146:147], v15 offset:10240
    s_waitcnt lgkmcnt(6)
    v_mfma_f32_16x16x32_bf16 v[100:103], v[60:63], v[148:151], v[100:103]
    v_mfma_f32_16x16x32_bf16 v[96:99], v[56:59], v[148:151], v[96:99]
    v_mfma_f32_16x16x32_bf16 v[92:95], v[52:55], v[148:151], v[92:95]
    v_mfma_f32_16x16x32_bf16 v[88:91], v[48:51], v[148:151], v[88:91]
    v_mfma_f32_16x16x32_bf16 v[84:87], v[44:47], v[148:151], v[84:87]
    ds_read_b64_tr_b16 v[148:149], v16 offset:8192
    ds_read_b64_tr_b16 v[150:151], v16 offset:10240
    s_waitcnt lgkmcnt(6)
    v_mfma_f32_16x16x32_bf16 v[104:107], v[44:47], v[152:155], v[104:107]
    s_add_u32 m0, s49, 13312
    s_add_u32 s57, s56, 81920
    buffer_load_dwordx4 v4, s[12:15], s57 offen lds
    v_mfma_f32_16x16x32_bf16 v[108:111], v[48:51], v[152:155], v[108:111]
    v_mfma_f32_16x16x32_bf16 v[112:115], v[52:55], v[152:155], v[112:115]
    v_mfma_f32_16x16x32_bf16 v[116:119], v[56:59], v[152:155], v[116:119]
    v_mfma_f32_16x16x32_bf16 v[120:123], v[60:63], v[152:155], v[120:123]
    ds_read_b64_tr_b16 v[152:153], v17 offset:8192
    ds_read_b64_tr_b16 v[154:155], v17 offset:10240
    s_waitcnt lgkmcnt(6)
    v_mfma_f32_16x16x32_bf16 v[140:143], v[60:63], v[156:159], v[140:143]
    s_add_u32 m0, s49, 4096
    s_nop 0
    buffer_load_dwordx4 v13, s[20:23], s64 offen offset:0 lds
    s_add_u32 s64, s64, 31744
    v_mfma_f32_16x16x32_bf16 v[136:139], v[56:59], v[156:159], v[136:139]
    buffer_load_dwordx4 v13, s[20:23], s64 offen offset:1024 lds
    s_add_u32 s64, s64, 31744
    v_mfma_f32_16x16x32_bf16 v[132:135], v[52:55], v[156:159], v[132:135]
    buffer_load_dwordx4 v13, s[20:23], s64 offen offset:2048 lds
    s_add_u32 s64, s64, 31744
    v_mfma_f32_16x16x32_bf16 v[128:131], v[48:51], v[156:159], v[128:131]
    buffer_load_dwordx4 v13, s[20:23], s64 offen offset:3072 lds
    s_add_u32 s64, s64, 35840
    v_mfma_f32_16x16x32_bf16 v[124:127], v[44:47], v[156:159], v[124:127]
    ds_read_b64_tr_b16 v[156:157], v18 offset:8192
    ds_read_b64_tr_b16 v[158:159], v18 offset:10240
    s_waitcnt vmcnt(5)
    s_waitcnt lgkmcnt(6)
    v_mfma_f32_16x16x32_bf16 v[64:67], v[24:27], v[144:147], v[64:67]
    buffer_load_dwordx4 v[44:47], v14, s[24:27], s65 offen offset:0 sc1
    v_mfma_f32_16x16x32_bf16 v[68:71], v[28:31], v[144:147], v[68:71]
    buffer_load_dwordx4 v[48:51], v14, s[24:27], s65 offen offset:256 sc1
    v_mfma_f32_16x16x32_bf16 v[72:75], v[32:35], v[144:147], v[72:75]
    buffer_load_dwordx4 v[52:55], v14, s[24:27], s65 offen offset:512 sc1
    v_mfma_f32_16x16x32_bf16 v[76:79], v[36:39], v[144:147], v[76:79]
    buffer_load_dwordx4 v[56:59], v14, s[24:27], s65 offen offset:768 sc1
    v_mfma_f32_16x16x32_bf16 v[80:83], v[40:43], v[144:147], v[80:83]
    buffer_load_dwordx4 v[60:63], v14, s[24:27], s65 offen offset:1024 sc1
    s_add_u32 s65, s65, 40960
    ds_read_b64_tr_b16 v[144:145], v15 offset:0
    ds_read_b64_tr_b16 v[146:147], v15 offset:2048
    s_waitcnt lgkmcnt(6)
    v_mfma_f32_16x16x32_bf16 v[100:103], v[40:43], v[148:151], v[100:103]
    v_mfma_f32_16x16x32_bf16 v[96:99], v[36:39], v[148:151], v[96:99]
    v_mfma_f32_16x16x32_bf16 v[92:95], v[32:35], v[148:151], v[92:95]
    v_mfma_f32_16x16x32_bf16 v[88:91], v[28:31], v[148:151], v[88:91]
    v_mfma_f32_16x16x32_bf16 v[84:87], v[24:27], v[148:151], v[84:87]
    ds_read_b64_tr_b16 v[148:149], v16 offset:0
    ds_read_b64_tr_b16 v[150:151], v16 offset:2048
    s_waitcnt lgkmcnt(6)
    v_mfma_f32_16x16x32_bf16 v[104:107], v[24:27], v[152:155], v[104:107]
    s_add_u32 m0, s49, 14336
    s_add_u32 s57, s56, 81920
    buffer_load_dwordx4 v5, s[12:15], s57 offen lds
    v_mfma_f32_16x16x32_bf16 v[108:111], v[28:31], v[152:155], v[108:111]
    v_mfma_f32_16x16x32_bf16 v[112:115], v[32:35], v[152:155], v[112:115]
    v_mfma_f32_16x16x32_bf16 v[116:119], v[36:39], v[152:155], v[116:119]
    v_mfma_f32_16x16x32_bf16 v[120:123], v[40:43], v[152:155], v[120:123]
    ds_read_b64_tr_b16 v[152:153], v17 offset:0
    ds_read_b64_tr_b16 v[154:155], v17 offset:2048
    s_waitcnt lgkmcnt(6)
    v_mfma_f32_16x16x32_bf16 v[140:143], v[40:43], v[156:159], v[140:143]
    s_add_u32 m0, s49, 8192
    s_nop 0
    buffer_load_dwordx4 v13, s[20:23], s64 offen offset:0 lds
    s_add_u32 s64, s64, 31744
    v_mfma_f32_16x16x32_bf16 v[136:139], v[36:39], v[156:159], v[136:139]
    buffer_load_dwordx4 v13, s[20:23], s64 offen offset:1024 lds
    s_add_u32 s64, s64, 31744
    v_mfma_f32_16x16x32_bf16 v[132:135], v[32:35], v[156:159], v[132:135]
    buffer_load_dwordx4 v13, s[20:23], s64 offen offset:2048 lds
    s_add_u32 s64, s64, 31744
    v_mfma_f32_16x16x32_bf16 v[128:131], v[28:31], v[156:159], v[128:131]
    buffer_load_dwordx4 v13, s[20:23], s64 offen offset:3072 lds
    s_add_u32 s64, s64, 35840
    v_mfma_f32_16x16x32_bf16 v[124:127], v[24:27], v[156:159], v[124:127]
    ds_read_b64_tr_b16 v[156:157], v18 offset:0
    ds_read_b64_tr_b16 v[158:159], v18 offset:2048
    s_waitcnt vmcnt(5)
    s_waitcnt lgkmcnt(0)
    v_mov_b32 v162, 2
    ds_write_b32 v160, v162
    s_waitcnt lgkmcnt(6)
    v_mfma_f32_16x16x32_bf16 v[64:67], v[44:47], v[144:147], v[64:67]
    buffer_load_dwordx4 v[24:27], v14, s[24:27], s65 offen offset:0 sc1
    v_mfma_f32_16x16x32_bf16 v[68:71], v[48:51], v[144:147], v[68:71]
    buffer_load_dwordx4 v[28:31], v14, s[24:27], s65 offen offset:256 sc1
    v_mfma_f32_16x16x32_bf16 v[72:75], v[52:55], v[144:147], v[72:75]
    buffer_load_dwordx4 v[32:35], v14, s[24:27], s65 offen offset:512 sc1
    v_mfma_f32_16x16x32_bf16 v[76:79], v[56:59], v[144:147], v[76:79]
    buffer_load_dwordx4 v[36:39], v14, s[24:27], s65 offen offset:768 sc1
    v_mfma_f32_16x16x32_bf16 v[80:83], v[60:63], v[144:147], v[80:83]
    buffer_load_dwordx4 v[40:43], v14, s[24:27], s65 offen offset:1024 sc1
    s_add_u32 s65, s65, 40960
    ds_read_b64_tr_b16 v[144:145], v15 offset:4096
    ds_read_b64_tr_b16 v[146:147], v15 offset:6144
    s_waitcnt lgkmcnt(6)
    v_mfma_f32_16x16x32_bf16 v[100:103], v[60:63], v[148:151], v[100:103]
    v_mfma_f32_16x16x32_bf16 v[96:99], v[56:59], v[148:151], v[96:99]
    v_mfma_f32_16x16x32_bf16 v[92:95], v[52:55], v[148:151], v[92:95]
    v_mfma_f32_16x16x32_bf16 v[88:91], v[48:51], v[148:151], v[88:91]
    v_mfma_f32_16x16x32_bf16 v[84:87], v[44:47], v[148:151], v[84:87]
    ds_read_b64_tr_b16 v[148:149], v16 offset:4096
    ds_read_b64_tr_b16 v[150:151], v16 offset:6144
    s_waitcnt lgkmcnt(6)
    v_mfma_f32_16x16x32_bf16 v[104:107], v[44:47], v[152:155], v[104:107]
    s_add_u32 m0, s49, 15360
    s_add_u32 s57, s56, 122880
    buffer_load_dwordx4 v1, s[12:15], s57 offen lds
    v_mfma_f32_16x16x32_bf16 v[108:111], v[48:51], v[152:155], v[108:111]
    v_mfma_f32_16x16x32_bf16 v[112:115], v[52:55], v[152:155], v[112:115]
    v_mfma_f32_16x16x32_bf16 v[116:119], v[56:59], v[152:155], v[116:119]
    v_mfma_f32_16x16x32_bf16 v[120:123], v[60:63], v[152:155], v[120:123]
    ds_read_b64_tr_b16 v[152:153], v17 offset:4096
    ds_read_b64_tr_b16 v[154:155], v17 offset:6144
    s_waitcnt lgkmcnt(6)
    v_mfma_f32_16x16x32_bf16 v[140:143], v[60:63], v[156:159], v[140:143]
    s_add_u32 m0, s49, 0
    s_add_u32 s57, s56, 0
    buffer_load_dwordx4 v1, s[12:15], s57 offen lds
    v_mfma_f32_16x16x32_bf16 v[136:139], v[56:59], v[156:159], v[136:139]
    s_add_u32 m0, s49, 1024
    s_add_u32 s57, s56, 0
    buffer_load_dwordx4 v2, s[12:15], s57 offen lds
    v_mfma_f32_16x16x32_bf16 v[132:135], v[52:55], v[156:159], v[132:135]
    s_add_u32 m0, s49, 2048
    s_add_u32 s57, s56, 0
    buffer_load_dwordx4 v3, s[12:15], s57 offen lds
    v_mfma_f32_16x16x32_bf16 v[128:131], v[48:51], v[156:159], v[128:131]
    s_add_u32 m0, s49, 3072
    s_add_u32 s57, s56, 0
    buffer_load_dwordx4 v4, s[12:15], s57 offen lds
    v_mfma_f32_16x16x32_bf16 v[124:127], v[44:47], v[156:159], v[124:127]
    ds_read_b64_tr_b16 v[156:157], v18 offset:4096
    ds_read_b64_tr_b16 v[158:159], v18 offset:6144
    s_waitcnt vmcnt(5)
    s_waitcnt lgkmcnt(6)
    v_mfma_f32_16x16x32_bf16 v[64:67], v[24:27], v[144:147], v[64:67]
    buffer_load_dwordx4 v[44:47], v14, s[24:27], s65 offen offset:0 sc1
    v_mfma_f32_16x16x32_bf16 v[68:71], v[28:31], v[144:147], v[68:71]
    buffer_load_dwordx4 v[48:51], v14, s[24:27], s65 offen offset:256 sc1
    v_mfma_f32_16x16x32_bf16 v[72:75], v[32:35], v[144:147], v[72:75]
    buffer_load_dwordx4 v[52:55], v14, s[24:27], s65 offen offset:512 sc1
    v_mfma_f32_16x16x32_bf16 v[76:79], v[36:39], v[144:147], v[76:79]
    buffer_load_dwordx4 v[56:59], v14, s[24:27], s65 offen offset:768 sc1
    v_mfma_f32_16x16x32_bf16 v[80:83], v[40:43], v[144:147], v[80:83]
    buffer_load_dwordx4 v[60:63], v14, s[24:27], s65 offen offset:1024 sc1
    s_add_u32 s65, s65, 40960
    ds_read_b64_tr_b16 v[144:145], v15 offset:8192
    ds_read_b64_tr_b16 v[146:147], v15 offset:10240
    s_waitcnt lgkmcnt(6)
    v_mfma_f32_16x16x32_bf16 v[100:103], v[40:43], v[148:151], v[100:103]
    v_mfma_f32_16x16x32_bf16 v[96:99], v[36:39], v[148:151], v[96:99]
    v_mfma_f32_16x16x32_bf16 v[92:95], v[32:35], v[148:151], v[92:95]
    v_mfma_f32_16x16x32_bf16 v[88:91], v[28:31], v[148:151], v[88:91]
    v_mfma_f32_16x16x32_bf16 v[84:87], v[24:27], v[148:151], v[84:87]
    ds_read_b64_tr_b16 v[148:149], v16 offset:8192
    ds_read_b64_tr_b16 v[150:151], v16 offset:10240
    s_waitcnt lgkmcnt(6)
    v_mfma_f32_16x16x32_bf16 v[104:107], v[24:27], v[152:155], v[104:107]
    s_add_u32 m0, s49, 16384
    s_add_u32 s57, s56, 122880
    buffer_load_dwordx4 v2, s[12:15], s57 offen lds
    v_mfma_f32_16x16x32_bf16 v[108:111], v[28:31], v[152:155], v[108:111]
    s_add_u32 m0, s49, 12288
    s_add_u32 s57, s56, 81920
    buffer_load_dwordx4 v3, s[12:15], s57 offen lds
    v_mfma_f32_16x16x32_bf16 v[112:115], v[32:35], v[152:155], v[112:115]
    v_mfma_f32_16x16x32_bf16 v[116:119], v[36:39], v[152:155], v[116:119]
    v_mfma_f32_16x16x32_bf16 v[120:123], v[40:43], v[152:155], v[120:123]
    ds_read_b64_tr_b16 v[152:153], v17 offset:8192
    ds_read_b64_tr_b16 v[154:155], v17 offset:10240
    s_waitcnt lgkmcnt(6)
    v_mfma_f32_16x16x32_bf16 v[140:143], v[40:43], v[156:159], v[140:143]
    s_add_u32 m0, s49, 4096
    s_add_u32 s57, s56, 0
    buffer_load_dwordx4 v5, s[12:15], s57 offen lds
    v_mfma_f32_16x16x32_bf16 v[136:139], v[36:39], v[156:159], v[136:139]
    s_add_u32 m0, s49, 5120
    s_add_u32 s57, s56, 40960
    buffer_load_dwordx4 v1, s[12:15], s57 offen lds
    v_mfma_f32_16x16x32_bf16 v[132:135], v[32:35], v[156:159], v[132:135]
    s_add_u32 m0, s49, 6144
    s_add_u32 s57, s56, 40960
    buffer_load_dwordx4 v2, s[12:15], s57 offen lds
    v_mfma_f32_16x16x32_bf16 v[128:131], v[28:31], v[156:159], v[128:131]
    s_add_u32 m0, s49, 7168
    s_add_u32 s57, s56, 40960
    buffer_load_dwordx4 v3, s[12:15], s57 offen lds
    v_mfma_f32_16x16x32_bf16 v[124:127], v[24:27], v[156:159], v[124:127]
    ds_read_b64_tr_b16 v[156:157], v18 offset:8192
    ds_read_b64_tr_b16 v[158:159], v18 offset:10240
    s_waitcnt vmcnt(6)
    s_waitcnt lgkmcnt(6)
    v_mfma_f32_16x16x32_bf16 v[64:67], v[44:47], v[144:147], v[64:67]
    v_mfma_f32_16x16x32_bf16 v[68:71], v[48:51], v[144:147], v[68:71]
    v_mfma_f32_16x16x32_bf16 v[72:75], v[52:55], v[144:147], v[72:75]
    v_mfma_f32_16x16x32_bf16 v[76:79], v[56:59], v[144:147], v[76:79]
    v_mfma_f32_16x16x32_bf16 v[80:83], v[60:63], v[144:147], v[80:83]
    s_waitcnt lgkmcnt(4)
    v_mfma_f32_16x16x32_bf16 v[100:103], v[60:63], v[148:151], v[100:103]
    v_mfma_f32_16x16x32_bf16 v[96:99], v[56:59], v[148:151], v[96:99]
    v_mfma_f32_16x16x32_bf16 v[92:95], v[52:55], v[148:151], v[92:95]
    v_mfma_f32_16x16x32_bf16 v[88:91], v[48:51], v[148:151], v[88:91]
    v_mfma_f32_16x16x32_bf16 v[84:87], v[44:47], v[148:151], v[84:87]
    s_waitcnt lgkmcnt(2)
    v_mfma_f32_16x16x32_bf16 v[104:107], v[44:47], v[152:155], v[104:107]
    s_add_u32 m0, s49, 17408
    s_add_u32 s57, s56, 122880
    buffer_load_dwordx4 v3, s[12:15], s57 offen lds
    v_mfma_f32_16x16x32_bf16 v[108:111], v[48:51], v[152:155], v[108:111]
    v_mfma_f32_16x16x32_bf16 v[112:115], v[52:55], v[152:155], v[112:115]
    v_mfma_f32_16x16x32_bf16 v[116:119], v[56:59], v[152:155], v[116:119]
    v_mfma_f32_16x16x32_bf16 v[120:123], v[60:63], v[152:155], v[120:123]
    s_waitcnt lgkmcnt(0)
    v_mfma_f32_16x16x32_bf16 v[140:143], v[60:63], v[156:159], v[140:143]
    s_add_u32 m0, s49, 8192
    s_add_u32 s57, s56, 40960
    buffer_load_dwordx4 v4, s[12:15], s57 offen lds
    v_mfma_f32_16x16x32_bf16 v[136:139], v[56:59], v[156:159], v[136:139]
    s_add_u32 m0, s49, 9216
    s_add_u32 s57, s56, 40960
    buffer_load_dwordx4 v5, s[12:15], s57 offen lds
    v_mfma_f32_16x16x32_bf16 v[132:135], v[52:55], v[156:159], v[132:135]
    s_add_u32 m0, s49, 10240
    s_add_u32 s57, s56, 81920
    buffer_load_dwordx4 v1, s[12:15], s57 offen lds
    v_mfma_f32_16x16x32_bf16 v[128:131], v[48:51], v[156:159], v[128:131]
    s_add_u32 m0, s49, 11264
    s_add_u32 s57, s56, 81920
    buffer_load_dwordx4 v2, s[12:15], s57 offen lds
    v_mfma_f32_16x16x32_bf16 v[124:127], v[44:47], v[156:159], v[124:127]
    s_setprio 3
    s_mov_b32 s45, 800000
gated_mix__mha_block__mixer_token_mlp__prompt_kernel_spin107:
    ds_read_b32 v163, v161 offset:0
    s_waitcnt lgkmcnt(0)
    v_cmp_gt_u32 vcc, 2, v163
    s_cbranch_vccz gated_mix__mha_block__mixer_token_mlp__prompt_kernel_spind108
    s_sleep 1
    s_sub_u32 s45, s45, 1
    s_cbranch_scc0 gated_mix__mha_block__mixer_token_mlp__prompt_kernel_spin107
gated_mix__mha_block__mixer_token_mlp__prompt_kernel_spind108:
    ds_read_b64_tr_b16 v[44:45], v6 offset:19200
    ds_read_b64_tr_b16 v[46:47], v6 offset:20480
    ds_read_b64_tr_b16 v[48:49], v6 offset:19232
    ds_read_b64_tr_b16 v[50:51], v6 offset:20512
    ds_read_b64_tr_b16 v[52:53], v6 offset:19264
    ds_read_b64_tr_b16 v[54:55], v6 offset:20544
    ds_read_b64_tr_b16 v[56:57], v6 offset:19296
    ds_read_b64_tr_b16 v[58:59], v6 offset:20576
    ds_read_b64_tr_b16 v[60:61], v6 offset:19328
    ds_read_b64_tr_b16 v[62:63], v6 offset:20608
    ds_read_b64_tr_b16 v[144:145], v6 offset:44800
    ds_read_b64_tr_b16 v[146:147], v6 offset:46080
    ds_read_b64_tr_b16 v[148:149], v6 offset:44832
    ds_read_b64_tr_b16 v[150:151], v6 offset:46112
    ds_read_b64_tr_b16 v[152:153], v6 offset:44864
    ds_read_b64_tr_b16 v[154:155], v6 offset:46144
    ds_read_b64_tr_b16 v[156:157], v6 offset:44896
    ds_read_b64_tr_b16 v[158:159], v6 offset:46176
    v_lshlrev_b32 v13, 4, v0
    s_mul_i32 s54, s48, 15360
    s_add_u32 s54, s54, 102400
    v_add_u32 v1, s54, v13
    s_add_u32 s54, s54, 14336
    s_cmp_eq_u32 s48, 3
    s_cselect_b32 s54, 19200, s54
    v_add_u32 v2, s54, v13
    s_xor_b32 s54, s48, 1
    s_mul_i32 s54, s54, 15360
    s_add_u32 s54, s54, 102400
    v_add_u32 v3, s54, v13
    s_xor_b32 s54, s48, 2
    s_mul_i32 s54, s54, 15360
    s_add_u32 s54, s54, 107520
    v_add_u32 v4, s54, v13
    s_xor_b32 s54, s48, 3
    s_mul_i32 s54, s54, 15360
    s_add_u32 s54, s54, 112640
    v_add_u32 v5, s54, v13
    s_add_u32 s54, s54, 4096
    s_cmp_eq_u32 s48, 0
    s_cselect_b32 s54, 19200, s54
    v_add_u32 v13, s54, v13
    v_and_b32 v14, 7, v0
    v_lshlrev_b32 v14, 2, v14
    v_add_u32 v14, 163584, v14
    v_sub_f32 v22, 1.0, v22
    v_mul_f32 v20, v20, v22
    s_lshl_b32 s56, s66, 4
    s_add_u32 s56, s56, 12582912
    s_lshr_b32 s54, s66, 5
    s_lshl_b32 s54, s54, 8
    s_add_u32 s54, s54, 15302656
    s_waitcnt lgkmcnt(0)
    v_mov_b32 v162, 3
    ds_write_b32 v160, v162
    s_mov_b32 s45, 800000
gated_mix__mha_block__mixer_token_mlp__prompt_kernel_spin109:
    ds_read_b32 v165, v14 offset:0
    s_waitcnt lgkmcnt(0)
    v_cmp_gt_u32 vcc, 17, v165
    s_cbranch_vccz gated_mix__mha_block__mixer_token_mlp__prompt_kernel_spind110
    s_sleep 8
    s_sub_u32 s45, s45, 1
    s_cbranch_scc0 gated_mix__mha_block__mixer_token_mlp__prompt_kernel_spin109
gated_mix__mha_block__mixer_token_mlp__prompt_kernel_spind110:
    s_mov_b32 s45, 800000
gated_mix__mha_block__mixer_token_mlp__prompt_kernel_spin111:
    ds_read_b32 v165, v14 offset:0
    s_waitcnt lgkmcnt(0)
    v_cmp_gt_u32 vcc, 20, v165
    s_cbranch_vccz gated_mix__mha_block__mixer_token_mlp__prompt_kernel_spind112
    s_sleep 1
    s_sub_u32 s45, s45, 1
    s_cbranch_scc0 gated_mix__mha_block__mixer_token_mlp__prompt_kernel_spin111
gated_mix__mha_block__mixer_token_mlp__prompt_kernel_spind112:
    ds_write_b128 v1, v[84:87] offset:0
    ds_write_b128 v1, v[88:91] offset:1024
    ds_write_b128 v1, v[92:95] offset:2048
    ds_write_b128 v1, v[96:99] offset:3072
    ds_write_b128 v1, v[100:103] offset:4096
    ds_write_b128 v1, v[104:107] offset:5120
    ds_write_b128 v1, v[108:111] offset:6144
    ds_write_b128 v1, v[112:115] offset:7168
    ds_write_b128 v1, v[116:119] offset:8192
    ds_write_b128 v1, v[120:123] offset:9216
    ds_write_b128 v1, v[124:127] offset:10240
    ds_write_b128 v1, v[128:131] offset:11264
    ds_write_b128 v1, v[132:135] offset:12288
    ds_write_b128 v1, v[136:139] offset:13312
    s_mov_b32 s45, 800000
gated_mix__mha_block__mixer_token_mlp__prompt_kernel_spin113:
    ds_read_b32 v163, v161 offset:0
    s_waitcnt lgkmcnt(0)
    v_cmp_gt_u32 vcc, 3, v163
    s_cbranch_vccz gated_mix__mha_block__mixer_token_mlp__prompt_kernel_spind114
    s_sleep 0
    s_sub_u32 s45, s45, 1
    s_cbranch_scc0 gated_mix__mha_block__mixer_token_mlp__prompt_kernel_spin113
gated_mix__mha_block__mixer_token_mlp__prompt_kernel_spind114:
    ds_write_b128 v2, v[140:143]
    s_waitcnt vmcnt(0)
    s_waitcnt lgkmcnt(0)
    v_mov_b32 v162, 4
    ds_write_b32 v160, v162
    s_mov_b32 s45, 800000
gated_mix__mha_block__mixer_token_mlp__prompt_kernel_spin115:
    ds_read_b32 v163, v161 offset:0
    s_waitcnt lgkmcnt(0)
    v_cmp_gt_u32 vcc, 4, v163
    s_cbranch_vccz gated_mix__mha_block__mixer_token_mlp__prompt_kernel_spind116
    s_sleep 0
    s_sub_u32 s45, s45, 1
    s_cbranch_scc0 gated_mix__mha_block__mixer_token_mlp__prompt_kernel_spin115
gated_mix__mha_block__mixer_token_mlp__prompt_kernel_spind116:
    s_mov_b64 exec, 1
    v_mov_b32 v15, 0
    v_mov_b32 v16, 0
    buffer_atomic_add v16, v15, s[24:27], s54 offen sc0 sc1
    s_mov_b64 exec, -1
    ds_read_b128 v[84:87], v3 offset:0
    ds_read_b128 v[88:91], v3 offset:1024
    ds_read_b128 v[92:95], v3 offset:2048
    ds_read_b128 v[96:99], v3 offset:3072
    ds_read_b128 v[100:103], v3 offset:4096
    ds_read_b128 v[104:107], v4 offset:0
    ds_read_b128 v[108:111], v4 offset:1024
    ds_read_b128 v[112:115], v4 offset:2048
    ds_read_b128 v[116:119], v4 offset:3072
    ds_read_b128 v[120:123], v4 offset:4096
    ds_read_b128 v[124:127], v5 offset:0
    ds_read_b128 v[128:131], v5 offset:1024
    ds_read_b128 v[132:135], v5 offset:2048
    ds_read_b128 v[136:139], v5 offset:3072
    ds_read_b128 v[140:143], v13
    s_waitcnt lgkmcnt(10)
.p2align 3
    v_pk_add_f32 v[64:65], v[64:65], v[84:85]
    v_pk_add_f32 v[66:67], v[66:67], v[86:87]
    v_pk_add_f32 v[68:69], v[68:69], v[88:89]
    v_pk_add_f32 v[70:71], v[70:71], v[90:91]
    v_pk_add_f32 v[72:73], v[72:73], v[92:93]
    v_pk_add_f32 v[74:75], v[74:75], v[94:95]
    v_pk_add_f32 v[76:77], v[76:77], v[96:97]
    v_pk_add_f32 v[78:79], v[78:79], v[98:99]
    v_pk_add_f32 v[80:81], v[80:81], v[100:101]
    v_pk_add_f32 v[82:83], v[82:83], v[102:103]
    s_waitcnt lgkmcnt(5)
.p2align 3
    v_pk_add_f32 v[64:65], v[64:65], v[104:105]
    v_pk_add_f32 v[66:67], v[66:67], v[106:107]
    v_pk_add_f32 v[68:69], v[68:69], v[108:109]
    v_pk_add_f32 v[70:71], v[70:71], v[110:111]
    v_pk_add_f32 v[72:73], v[72:73], v[112:113]
    v_pk_add_f32 v[74:75], v[74:75], v[114:115]
    v_pk_add_f32 v[76:77], v[76:77], v[116:117]
    v_pk_add_f32 v[78:79], v[78:79], v[118:119]
    v_pk_add_f32 v[80:81], v[80:81], v[120:121]
    v_pk_add_f32 v[82:83], v[82:83], v[122:123]
    s_waitcnt lgkmcnt(0)
.p2align 3
    v_pk_add_f32 v[64:65], v[64:65], v[124:125]
    v_pk_add_f32 v[66:67], v[66:67], v[126:127]
    v_pk_add_f32 v[68:69], v[68:69], v[128:129]
    v_pk_add_f32 v[70:71], v[70:71], v[130:131]
    v_pk_add_f32 v[72:73], v[72:73], v[132:133]
    v_pk_add_f32 v[74:75], v[74:75], v[134:135]
    v_pk_add_f32 v[76:77], v[76:77], v[136:137]
    v_pk_add_f32 v[78:79], v[78:79], v[138:139]
    v_pk_add_f32 v[80:81], v[80:81], v[140:141]
    v_pk_add_f32 v[82:83], v[82:83], v[142:143]
    v_pk_fma_f32 v[24:25], v[64:65], v[22:23], v[20:21] op_sel_hi:[1,0,0]
    v_pk_fma_f32 v[26:27], v[66:67], v[22:23], v[20:21] op_sel_hi:[1,0,0]
    v_pk_fma_f32 v[28:29], v[68:69], v[22:23], v[20:21] op_sel_hi:[1,0,0]
    v_pk_fma_f32 v[30:31], v[70:71], v[22:23], v[20:21] op_sel_hi:[1,0,0]
    v_pk_fma_f32 v[32:33], v[72:73], v[22:23], v[20:21] op_sel_hi:[1,0,0]
    v_pk_fma_f32 v[34:35], v[74:75], v[22:23], v[20:21] op_sel_hi:[1,0,0]
    v_pk_fma_f32 v[36:37], v[76:77], v[22:23], v[20:21] op_sel_hi:[1,0,0]
    v_pk_fma_f32 v[38:39], v[78:79], v[22:23], v[20:21] op_sel_hi:[1,0,0]
    v_pk_fma_f32 v[40:41], v[80:81], v[22:23], v[20:21] op_sel_hi:[1,0,0]
    v_pk_fma_f32 v[42:43], v[82:83], v[22:23], v[20:21] op_sel_hi:[1,0,0]
    ds_read_b64_tr_b16 v[100:101], v6 offset:44928
    ds_read_b64_tr_b16 v[102:103], v6 offset:46208
    ds_read_b64_tr_b16 v[104:105], v7 offset:19200
    ds_read_b64_tr_b16 v[106:107], v7 offset:20480
    ds_read_b64_tr_b16 v[108:109], v7 offset:19232
    ds_read_b64_tr_b16 v[110:111], v7 offset:20512
    ds_read_b64_tr_b16 v[112:113], v7 offset:19264
    ds_read_b64_tr_b16 v[114:115], v7 offset:20544
    ds_read_b64_tr_b16 v[116:117], v7 offset:19296
    ds_read_b64_tr_b16 v[118:119], v7 offset:20576
    ds_read_b64_tr_b16 v[120:121], v7 offset:19328
    ds_read_b64_tr_b16 v[122:123], v7 offset:20608
    ds_read_b64_tr_b16 v[124:125], v7 offset:44800
    ds_read_b64_tr_b16 v[126:127], v7 offset:46080
    ds_read_b64_tr_b16 v[128:129], v7 offset:44832
    ds_read_b64_tr_b16 v[130:131], v7 offset:46112
    ds_read_b64_tr_b16 v[132:133], v7 offset:44864
    ds_read_b64_tr_b16 v[134:135], v7 offset:46144
    ds_read_b64_tr_b16 v[136:137], v7 offset:44896
    ds_read_b64_tr_b16 v[138:139], v7 offset:46176
    ds_read_b64_tr_b16 v[140:141], v7 offset:44928
    ds_read_b64_tr_b16 v[142:143], v7 offset:46208
    s_mov_b32 s45, 200000
    s_mov_b64 exec, 1
    s_branch gated_mix__mha_block__mixer_token_mlp__prompt_kernel_apollc119
gated_mix__mha_block__mixer_token_mlp__prompt_kernel_apoll117:
    s_mov_b64 exec, 1
    v_mov_b32 v15, 0
    v_mov_b32 v16, 0
    buffer_atomic_add v16, v15, s[24:27], s54 offen sc0 sc1
gated_mix__mha_block__mixer_token_mlp__prompt_kernel_apollc119:
    s_waitcnt vmcnt(0)
    v_cmp_gt_u32 vcc, 32, v16
    s_cbranch_vccz gated_mix__mha_block__mixer_token_mlp__prompt_kernel_apolld118
    s_sleep 2
    s_sub_u32 s45, s45, 1
    s_cbranch_scc0 gated_mix__mha_block__mixer_token_mlp__prompt_kernel_apoll117
gated_mix__mha_block__mixer_token_mlp__prompt_kernel_apolld118:
    s_mov_b64 exec, -1
    s_add_u32 s57, s56, 393216
    buffer_load_dwordx4 v[64:67], v12, s[24:27], s57 offen sc1
    s_add_u32 s57, s56, 917504
    buffer_load_dwordx4 v[68:71], v12, s[24:27], s57 offen sc1
    s_add_u32 s57, s56, 1441792
    buffer_load_dwordx4 v[72:75], v12, s[24:27], s57 offen sc1
    s_add_u32 s57, s56, 1966080
    buffer_load_dwordx4 v[76:79], v12, s[24:27], s57 offen sc1
    s_add_u32 s57, s56, 0
    buffer_load_dwordx4 v[80:83], v12, s[24:27], s57 offen sc1
    s_add_u32 s57, s56, 131072
    buffer_load_dwordx4 v[84:87], v12, s[24:27], s57 offen sc1
    s_add_u32 s57, s56, 262144
    buffer_load_dwordx4 v[88:91], v12, s[24:27], s57 offen sc1
    s_add_u32 s57, s56, 524288
    buffer_load_dwordx4 v[92:95], v12, s[24:27], s57 offen sc1
    s_lshl_b32 s58, s66, 3
    s_add_u32 s58, s58, 12582912
    v_lshrrev_b32 v3, 4, v0
    v_and_b32 v4, 1, v3
    v_lshl_add_u32 v3, v3, 1, v4
    v_lshlrev_b32 v3, 14, v3
    v_and_b32 v4, 15, v0
    v_lshl_add_u32 v3, v4, 3, v3
    v_xor_b32 v4, 0x4000, v3
    s_xor_b32 s55, s48, 1
    s_mul_i32 s55, s55, 15360
    s_add_u32 s55, s55, 102400
    v_and_b32 v17, 15, v0
    v_mul_u32_u24 v17, 160, v17
    v_lshrrev_b32 v18, 4, v0
    v_lshl_add_u32 v17, v18, 3, v17
    v_add_u32 v17, s55, v17
    v_lshlrev_b32 v18, 4, v0
    v_add_u32 v18, s55, v18
    v_add_u32 v1, 0, v0
    v_mul_u32_u24 v2, 6554, v1
    v_lshrrev_b32 v2, 16, v2
    v_mul_u32_u24 v2, 1120, v2
    v_lshl_add_u32 v13, v1, 4, v2
    v_add_u32 v1, 64, v0
    v_mul_u32_u24 v2, 6554, v1
    v_lshrrev_b32 v2, 16, v2
    v_mul_u32_u24 v2, 1120, v2
    v_lshl_add_u32 v14, v1, 4, v2
    v_add_u32 v1, 128, v0
    v_mul_u32_u24 v2, 6554, v1
    v_lshrrev_b32 v2, 16, v2
    v_mul_u32_u24 v2, 1120, v2
    v_lshl_add_u32 v15, v1, 4, v2
    s_waitcnt lgkmcnt(0)
    s_waitcnt vmcnt(7)
    v_mfma_f32_16x16x32_bf16 v[24:27], v[44:47], v[64:67], v[24:27]
    ds_read_b64_tr_b16 v[44:45], v6 offset:0
    ds_read_b64_tr_b16 v[46:47], v6 offset:1280
    v_mfma_f32_16x16x32_bf16 v[28:31], v[48:51], v[64:67], v[28:31]
    ds_read_b64_tr_b16 v[48:49], v6 offset:32
    ds_read_b64_tr_b16 v[50:51], v6 offset:1312
    v_mfma_f32_16x16x32_bf16 v[32:35], v[52:55], v[64:67], v[32:35]
    ds_read_b64_tr_b16 v[52:53], v6 offset:64
    ds_read_b64_tr_b16 v[54:55], v6 offset:1344
    v_mfma_f32_16x16x32_bf16 v[36:39], v[56:59], v[64:67], v[36:39]
    ds_read_b64_tr_b16 v[56:57], v6 offset:96
    ds_read_b64_tr_b16 v[58:59], v6 offset:1376
    v_mfma_f32_16x16x32_bf16 v[40:43], v[60:63], v[64:67], v[40:43]
    ds_read_b64_tr_b16 v[60:61], v6 offset:128
    ds_read_b64_tr_b16 v[62:63], v6 offset:1408
    s_add_u32 s57, s56, 655360
    buffer_load_dwordx4 v[96:99], v12, s[24:27], s57 offen sc1
    s_waitcnt vmcnt(7)
    v_mfma_f32_16x16x32_bf16 v[24:27], v[144:147], v[68:71], v[24:27]
    ds_read_b64_tr_b16 v[144:145], v6 offset:6400
    ds_read_b64_tr_b16 v[146:147], v6 offset:7680
    v_mfma_f32_16x16x32_bf16 v[28:31], v[148:151], v[68:71], v[28:31]
    ds_read_b64_tr_b16 v[148:149], v6 offset:6432
    ds_read_b64_tr_b16 v[150:151], v6 offset:7712
    v_mfma_f32_16x16x32_bf16 v[32:35], v[152:155], v[68:71], v[32:35]
    ds_read_b64_tr_b16 v[152:153], v6 offset:6464
    ds_read_b64_tr_b16 v[154:155], v6 offset:7744
    v_mfma_f32_16x16x32_bf16 v[36:39], v[156:159], v[68:71], v[36:39]
    v_mfma_f32_16x16x32_bf16 v[40:43], v[100:103], v[68:71], v[40:43]
    ds_read_b64_tr_b16 v[156:157], v6 offset:6496
    ds_read_b64_tr_b16 v[158:159], v6 offset:7776
    s_add_u32 s57, s56, 786432
    buffer_load_dwordx4 v[64:67], v12, s[24:27], s57 offen sc1
    s_waitcnt vmcnt(7)
    v_mfma_f32_16x16x32_bf16 v[24:27], v[104:107], v[72:75], v[24:27]
    ds_read_b64_tr_b16 v[100:101], v6 offset:6528
    ds_read_b64_tr_b16 v[102:103], v6 offset:7808
    v_mfma_f32_16x16x32_bf16 v[28:31], v[108:111], v[72:75], v[28:31]
    ds_read_b64_tr_b16 v[104:105], v6 offset:12800
    ds_read_b64_tr_b16 v[106:107], v6 offset:14080
    v_mfma_f32_16x16x32_bf16 v[32:35], v[112:115], v[72:75], v[32:35]
    ds_read_b64_tr_b16 v[108:109], v6 offset:12832
    ds_read_b64_tr_b16 v[110:111], v6 offset:14112
    v_mfma_f32_16x16x32_bf16 v[36:39], v[116:119], v[72:75], v[36:39]
    ds_read_b64_tr_b16 v[112:113], v6 offset:12864
    ds_read_b64_tr_b16 v[114:115], v6 offset:14144
    v_mfma_f32_16x16x32_bf16 v[40:43], v[120:123], v[72:75], v[40:43]
    ds_read_b64_tr_b16 v[116:117], v6 offset:12896
    ds_read_b64_tr_b16 v[118:119], v6 offset:14176
    s_add_u32 s57, s56, 1048576
    buffer_load_dwordx4 v[68:71], v12, s[24:27], s57 offen sc1
    s_waitcnt vmcnt(7)
    v_mfma_f32_16x16x32_bf16 v[24:27], v[124:127], v[76:79], v[24:27]
    ds_read_b64_tr_b16 v[120:121], v6 offset:12928
    ds_read_b64_tr_b16 v[122:123], v6 offset:14208
    v_mfma_f32_16x16x32_bf16 v[28:31], v[128:131], v[76:79], v[28:31]
    v_mfma_f32_16x16x32_bf16 v[32:35], v[132:135], v[76:79], v[32:35]
    ds_read_b64_tr_b16 v[124:125], v6 offset:25600
    ds_read_b64_tr_b16 v[126:127], v6 offset:26880
    v_mfma_f32_16x16x32_bf16 v[36:39], v[136:139], v[76:79], v[36:39]
    ds_read_b64_tr_b16 v[128:129], v6 offset:25632
    ds_read_b64_tr_b16 v[130:131], v6 offset:26912
    v_mfma_f32_16x16x32_bf16 v[40:43], v[140:143], v[76:79], v[40:43]
    ds_read_b64_tr_b16 v[132:133], v6 offset:25664
    ds_read_b64_tr_b16 v[134:135], v6 offset:26944
    s_add_u32 s57, s56, 1179648
    buffer_load_dwordx4 v[72:75], v12, s[24:27], s57 offen sc1
    s_waitcnt vmcnt(7) lgkmcnt(15)
    v_mfma_f32_16x16x32_bf16 v[24:27], v[44:47], v[80:83], v[24:27]
    ds_read_b64_tr_b16 v[136:137], v6 offset:25696
    ds_read_b64_tr_b16 v[138:139], v6 offset:26976
    v_mfma_f32_16x16x32_bf16 v[28:31], v[48:51], v[80:83], v[28:31]
    ds_read_b64_tr_b16 v[140:141], v6 offset:25728
    ds_read_b64_tr_b16 v[142:143], v6 offset:27008
    v_mfma_f32_16x16x32_bf16 v[32:35], v[52:55], v[80:83], v[32:35]
    ds_read_b64_tr_b16 v[44:45], v6 offset:32000
    ds_read_b64_tr_b16 v[46:47], v6 offset:33280
    s_waitcnt lgkmcnt(15)
    v_mfma_f32_16x16x32_bf16 v[36:39], v[56:59], v[80:83], v[36:39]
    ds_read_b64_tr_b16 v[48:49], v6 offset:32032
    ds_read_b64_tr_b16 v[50:51], v6 offset:33312
    v_mfma_f32_16x16x32_bf16 v[40:43], v[60:63], v[80:83], v[40:43]
    s_add_u32 s57, s56, 1310720
    buffer_load_dwordx4 v[76:79], v12, s[24:27], s57 offen sc1
    s_waitcnt vmcnt(7) lgkmcnt(15)
    v_mfma_f32_16x16x32_bf16 v[24:27], v[144:147], v[84:87], v[24:27]
    ds_read_b64_tr_b16 v[52:53], v6 offset:32064
    ds_read_b64_tr_b16 v[54:55], v6 offset:33344
    v_mfma_f32_16x16x32_bf16 v[28:31], v[148:151], v[84:87], v[28:31]
    ds_read_b64_tr_b16 v[56:57], v6 offset:32096
    ds_read_b64_tr_b16 v[58:59], v6 offset:33376
    v_mfma_f32_16x16x32_bf16 v[32:35], v[152:155], v[84:87], v[32:35]
    ds_read_b64_tr_b16 v[60:61], v6 offset:32128
    ds_read_b64_tr_b16 v[62:63], v6 offset:33408
    s_waitcnt lgkmcnt(15)
    v_mfma_f32_16x16x32_bf16 v[36:39], v[156:159], v[84:87], v[36:39]
    ds_read_b64_tr_b16 v[144:145], v6 offset:38400
    ds_read_b64_tr_b16 v[146:147], v6 offset:39680
    v_mfma_f32_16x16x32_bf16 v[40:43], v[100:103], v[84:87], v[40:43]
    ds_read_b64_tr_b16 v[148:149], v6 offset:38432
    ds_read_b64_tr_b16 v[150:151], v6 offset:39712
    s_add_u32 s57, s56, 1572864
    buffer_load_dwordx4 v[80:83], v12, s[24:27], s57 offen sc1
    s_waitcnt vmcnt(7) lgkmcnt(15)
    v_mfma_f32_16x16x32_bf16 v[24:27], v[104:107], v[88:91], v[24:27]
    ds_read_b64_tr_b16 v[152:153], v6 offset:38464
    ds_read_b64_tr_b16 v[154:155], v6 offset:39744
    v_mfma_f32_16x16x32_bf16 v[28:31], v[108:111], v[88:91], v[28:31]
    ds_read_b64_tr_b16 v[156:157], v6 offset:38496
    ds_read_b64_tr_b16 v[158:159], v6 offset:39776
    v_mfma_f32_16x16x32_bf16 v[32:35], v[112:115], v[88:91], v[32:35]
    s_waitcnt lgkmcnt(15)
    v_mfma_f32_16x16x32_bf16 v[36:39], v[116:119], v[88:91], v[36:39]
    ds_read_b64_tr_b16 v[100:101], v6 offset:38528
    ds_read_b64_tr_b16 v[102:103], v6 offset:39808
    v_mfma_f32_16x16x32_bf16 v[40:43], v[120:123], v[88:91], v[40:43]
    ds_read_b64_tr_b16 v[104:105], v7 offset:0
    ds_read_b64_tr_b16 v[106:107], v7 offset:1280
    s_add_u32 s57, s56, 1703936
    buffer_load_dwordx4 v[84:87], v12, s[24:27], s57 offen sc1
    s_waitcnt vmcnt(7) lgkmcnt(15)
    v_mfma_f32_16x16x32_bf16 v[24:27], v[124:127], v[92:95], v[24:27]
    ds_read_b64_tr_b16 v[108:109], v7 offset:32
    ds_read_b64_tr_b16 v[110:111], v7 offset:1312
    v_mfma_f32_16x16x32_bf16 v[28:31], v[128:131], v[92:95], v[28:31]
    ds_read_b64_tr_b16 v[112:113], v7 offset:64
    ds_read_b64_tr_b16 v[114:115], v7 offset:1344
    v_mfma_f32_16x16x32_bf16 v[32:35], v[132:135], v[92:95], v[32:35]
    ds_read_b64_tr_b16 v[116:117], v7 offset:96
    ds_read_b64_tr_b16 v[118:119], v7 offset:1376
    s_waitcnt lgkmcnt(15)
    v_mfma_f32_16x16x32_bf16 v[36:39], v[136:139], v[92:95], v[36:39]
    ds_read_b64_tr_b16 v[120:121], v7 offset:128
    ds_read_b64_tr_b16 v[122:123], v7 offset:1408
    v_mfma_f32_16x16x32_bf16 v[40:43], v[140:143], v[92:95], v[40:43]
    ds_read_b64_tr_b16 v[124:125], v7 offset:6400
    ds_read_b64_tr_b16 v[126:127], v7 offset:7680
    s_add_u32 s57, s56, 1835008
    buffer_load_dwordx4 v[88:91], v12, s[24:27], s57 offen sc1
    s_waitcnt vmcnt(7) lgkmcnt(15)
    v_mfma_f32_16x16x32_bf16 v[24:27], v[44:47], v[96:99], v[24:27]
    v_mfma_f32_16x16x32_bf16 v[28:31], v[48:51], v[96:99], v[28:31]
    ds_read_b64_tr_b16 v[128:129], v7 offset:6432
    ds_read_b64_tr_b16 v[130:131], v7 offset:7712
    v_mfma_f32_16x16x32_bf16 v[32:35], v[52:55], v[96:99], v[32:35]
    ds_read_b64_tr_b16 v[132:133], v7 offset:6464
    ds_read_b64_tr_b16 v[134:135], v7 offset:7744
    s_waitcnt lgkmcnt(15)
    v_mfma_f32_16x16x32_bf16 v[36:39], v[56:59], v[96:99], v[36:39]
    ds_read_b64_tr_b16 v[136:137], v7 offset:6496
    ds_read_b64_tr_b16 v[138:139], v7 offset:7776
    v_mfma_f32_16x16x32_bf16 v[40:43], v[60:63], v[96:99], v[40:43]
    ds_read_b64_tr_b16 v[140:141], v7 offset:6528
    ds_read_b64_tr_b16 v[142:143], v7 offset:7808
    s_add_u32 s57, s58, 2097152
    buffer_load_dwordx2 v[92:93], v3, s[24:27], s57 offen sc1
    buffer_load_dwordx2 v[94:95], v4, s[24:27], s57 offen sc1
    s_waitcnt vmcnt(8) lgkmcnt(15)
    v_mfma_f32_16x16x32_bf16 v[24:27], v[144:147], v[64:67], v[24:27]
    ds_read_b64_tr_b16 v[44:45], v7 offset:12800
    ds_read_b64_tr_b16 v[46:47], v7 offset:14080
    v_mfma_f32_16x16x32_bf16 v[28:31], v[148:151], v[64:67], v[28:31]
    ds_read_b64_tr_b16 v[48:49], v7 offset:12832
    ds_read_b64_tr_b16 v[50:51], v7 offset:14112
    v_mfma_f32_16x16x32_bf16 v[32:35], v[152:155], v[64:67], v[32:35]
    ds_read_b64_tr_b16 v[52:53], v7 offset:12864
    ds_read_b64_tr_b16 v[54:55], v7 offset:14144
    s_waitcnt lgkmcnt(15)
    v_mfma_f32_16x16x32_bf16 v[36:39], v[156:159], v[64:67], v[36:39]
    ds_read_b64_tr_b16 v[56:57], v7 offset:12896
    ds_read_b64_tr_b16 v[58:59], v7 offset:14176
    v_mfma_f32_16x16x32_bf16 v[40:43], v[100:103], v[64:67], v[40:43]
    s_add_u32 s57, s58, 2228224
    buffer_load_dwordx2 v[96:97], v3, s[24:27], s57 offen sc1
    buffer_load_dwordx2 v[98:99], v4, s[24:27], s57 offen sc1
    s_waitcnt vmcnt(9) lgkmcnt(15)
    v_mfma_f32_16x16x32_bf16 v[24:27], v[104:107], v[68:71], v[24:27]
    ds_read_b64_tr_b16 v[60:61], v7 offset:12928
    ds_read_b64_tr_b16 v[62:63], v7 offset:14208
    v_mfma_f32_16x16x32_bf16 v[28:31], v[108:111], v[68:71], v[28:31]
    ds_read_b64_tr_b16 v[144:145], v7 offset:25600
    ds_read_b64_tr_b16 v[146:147], v7 offset:26880
    v_mfma_f32_16x16x32_bf16 v[32:35], v[112:115], v[68:71], v[32:35]
    ds_read_b64_tr_b16 v[148:149], v7 offset:25632
    ds_read_b64_tr_b16 v[150:151], v7 offset:26912
    s_waitcnt lgkmcnt(15)
    v_mfma_f32_16x16x32_bf16 v[36:39], v[116:119], v[68:71], v[36:39]
    ds_read_b64_tr_b16 v[152:153], v7 offset:25664
    ds_read_b64_tr_b16 v[154:155], v7 offset:26944
    v_mfma_f32_16x16x32_bf16 v[40:43], v[120:123], v[68:71], v[40:43]
    ds_read_b64_tr_b16 v[156:157], v7 offset:25696
    ds_read_b64_tr_b16 v[158:159], v7 offset:26976
    s_add_u32 s57, s58, 2359296
    buffer_load_dwordx2 v[64:65], v3, s[24:27], s57 offen sc1
    buffer_load_dwordx2 v[66:67], v4, s[24:27], s57 offen sc1
    s_waitcnt vmcnt(10) lgkmcnt(15)
    v_mfma_f32_16x16x32_bf16 v[24:27], v[124:127], v[72:75], v[24:27]
    ds_read_b64_tr_b16 v[100:101], v7 offset:25728
    ds_read_b64_tr_b16 v[102:103], v7 offset:27008
    v_mfma_f32_16x16x32_bf16 v[28:31], v[128:131], v[72:75], v[28:31]
    ds_read_b64_tr_b16 v[104:105], v7 offset:32000
    ds_read_b64_tr_b16 v[106:107], v7 offset:33280
    v_mfma_f32_16x16x32_bf16 v[32:35], v[132:135], v[72:75], v[32:35]
    s_waitcnt lgkmcnt(15)
    v_mfma_f32_16x16x32_bf16 v[36:39], v[136:139], v[72:75], v[36:39]
    ds_read_b64_tr_b16 v[108:109], v7 offset:32032
    ds_read_b64_tr_b16 v[110:111], v7 offset:33312
    v_mfma_f32_16x16x32_bf16 v[40:43], v[140:143], v[72:75], v[40:43]
    ds_read_b64_tr_b16 v[112:113], v7 offset:32064
    ds_read_b64_tr_b16 v[114:115], v7 offset:33344
    s_add_u32 s57, s58, 2490368
    buffer_load_dwordx2 v[68:69], v3, s[24:27], s57 offen sc1
    buffer_load_dwordx2 v[70:71], v4, s[24:27], s57 offen sc1
    s_waitcnt vmcnt(11) lgkmcnt(15)
    v_mfma_f32_16x16x32_bf16 v[24:27], v[44:47], v[76:79], v[24:27]
    ds_read_b64_tr_b16 v[116:117], v7 offset:32096
    ds_read_b64_tr_b16 v[118:119], v7 offset:33376
    v_mfma_f32_16x16x32_bf16 v[28:31], v[48:51], v[76:79], v[28:31]
    ds_read_b64_tr_b16 v[120:121], v7 offset:32128
    ds_read_b64_tr_b16 v[122:123], v7 offset:33408
    v_mfma_f32_16x16x32_bf16 v[32:35], v[52:55], v[76:79], v[32:35]
    ds_read_b64_tr_b16 v[124:125], v7 offset:38400
    ds_read_b64_tr_b16 v[126:127], v7 offset:39680
    s_waitcnt lgkmcnt(15)
    v_mfma_f32_16x16x32_bf16 v[36:39], v[56:59], v[76:79], v[36:39]
    ds_read_b64_tr_b16 v[128:129], v7 offset:38432
    ds_read_b64_tr_b16 v[130:131], v7 offset:39712
    v_mfma_f32_16x16x32_bf16 v[40:43], v[60:63], v[76:79], v[40:43]
    ds_read_b64_tr_b16 v[132:133], v7 offset:38464
    ds_read_b64_tr_b16 v[134:135], v7 offset:39744
    s_waitcnt vmcnt(10) lgkmcnt(15)
    v_mfma_f32_16x16x32_bf16 v[24:27], v[144:147], v[80:83], v[24:27]
    v_mfma_f32_16x16x32_bf16 v[28:31], v[148:151], v[80:83], v[28:31]
    ds_read_b64_tr_b16 v[136:137], v7 offset:38496
    ds_read_b64_tr_b16 v[138:139], v7 offset:39776
    v_mfma_f32_16x16x32_bf16 v[32:35], v[152:155], v[80:83], v[32:35]
    ds_read_b64_tr_b16 v[140:141], v7 offset:38528
    ds_read_b64_tr_b16 v[142:143], v7 offset:39808
    s_waitcnt lgkmcnt(15)
    v_mfma_f32_16x16x32_bf16 v[36:39], v[156:159], v[80:83], v[36:39]
    ds_read_b64_tr_b16 v[44:45], v8 offset:0
    ds_read_b64_tr_b16 v[46:47], v9 offset:0
    v_mfma_f32_16x16x32_bf16 v[40:43], v[100:103], v[80:83], v[40:43]
    ds_read_b64_tr_b16 v[48:49], v8 offset:32
    ds_read_b64_tr_b16 v[50:51], v9 offset:32
    s_waitcnt vmcnt(9) lgkmcnt(15)
    v_mfma_f32_16x16x32_bf16 v[24:27], v[104:107], v[84:87], v[24:27]
    ds_read_b64_tr_b16 v[52:53], v8 offset:64
    ds_read_b64_tr_b16 v[54:55], v9 offset:64
    v_mfma_f32_16x16x32_bf16 v[28:31], v[108:111], v[84:87], v[28:31]
    ds_read_b64_tr_b16 v[56:57], v8 offset:96
    ds_read_b64_tr_b16 v[58:59], v9 offset:96
    v_mfma_f32_16x16x32_bf16 v[32:35], v[112:115], v[84:87], v[32:35]
    ds_read_b64_tr_b16 v[60:61], v8 offset:128
    ds_read_b64_tr_b16 v[62:63], v9 offset:128
    s_waitcnt lgkmcnt(15)
    v_mfma_f32_16x16x32_bf16 v[36:39], v[116:119], v[84:87], v[36:39]
    v_mfma_f32_16x16x32_bf16 v[40:43], v[120:123], v[84:87], v[40:43]
    ds_read_b64_tr_b16 v[144:145], v8 offset:25600
    ds_read_b64_tr_b16 v[146:147], v9 offset:25600
    s_waitcnt vmcnt(8) lgkmcnt(15)
    v_mfma_f32_16x16x32_bf16 v[24:27], v[124:127], v[88:91], v[24:27]
    ds_read_b64_tr_b16 v[148:149], v8 offset:25632
    ds_read_b64_tr_b16 v[150:151], v9 offset:25632
    v_mfma_f32_16x16x32_bf16 v[28:31], v[128:131], v[88:91], v[28:31]
    ds_read_b64_tr_b16 v[152:153], v8 offset:25664
    ds_read_b64_tr_b16 v[154:155], v9 offset:25664
    v_mfma_f32_16x16x32_bf16 v[32:35], v[132:135], v[88:91], v[32:35]
    ds_read_b64_tr_b16 v[156:157], v8 offset:25696
    ds_read_b64_tr_b16 v[158:159], v9 offset:25696
    s_waitcnt lgkmcnt(15)
    v_mfma_f32_16x16x32_bf16 v[36:39], v[136:139], v[88:91], v[36:39]
    ds_read_b64_tr_b16 v[100:101], v8 offset:25728
    ds_read_b64_tr_b16 v[102:103], v9 offset:25728
    v_mfma_f32_16x16x32_bf16 v[40:43], v[140:143], v[88:91], v[40:43]
    ds_read_b64_tr_b16 v[104:105], v10 offset:0
    ds_read_b64_tr_b16 v[106:107], v11 offset:0
    s_waitcnt vmcnt(6) lgkmcnt(15)
    v_mfma_f32_16x16x32_bf16 v[24:27], v[44:47], v[92:95], v[24:27]
    ds_read_b64_tr_b16 v[108:109], v10 offset:32
    ds_read_b64_tr_b16 v[110:111], v11 offset:32
    v_mfma_f32_16x16x32_bf16 v[28:31], v[48:51], v[92:95], v[28:31]
    v_mfma_f32_16x16x32_bf16 v[32:35], v[52:55], v[92:95], v[32:35]
    ds_read_b64_tr_b16 v[112:113], v10 offset:64
    ds_read_b64_tr_b16 v[114:115], v11 offset:64
    s_waitcnt lgkmcnt(15)
    v_mfma_f32_16x16x32_bf16 v[36:39], v[56:59], v[92:95], v[36:39]
    ds_read_b64_tr_b16 v[116:117], v10 offset:96
    ds_read_b64_tr_b16 v[118:119], v11 offset:96
    v_mfma_f32_16x16x32_bf16 v[40:43], v[60:63], v[92:95], v[40:43]
    ds_read_b64_tr_b16 v[120:121], v10 offset:128
    ds_read_b64_tr_b16 v[122:123], v11 offset:128
    s_waitcnt vmcnt(4) lgkmcnt(14)
    v_mfma_f32_16x16x32_bf16 v[24:27], v[144:147], v[96:99], v[24:27]
    ds_read_b64_tr_b16 v[124:125], v10 offset:25600
    ds_read_b64_tr_b16 v[126:127], v11 offset:25600
    v_mfma_f32_16x16x32_bf16 v[28:31], v[148:151], v[96:99], v[28:31]
    ds_read_b64_tr_b16 v[128:129], v10 offset:25632
    ds_read_b64_tr_b16 v[130:131], v11 offset:25632
    v_mfma_f32_16x16x32_bf16 v[32:35], v[152:155], v[96:99], v[32:35]
    ds_read_b64_tr_b16 v[132:133], v10 offset:25664
    ds_read_b64_tr_b16 v[134:135], v11 offset:25664
    s_waitcnt lgkmcnt(15)
    v_mfma_f32_16x16x32_bf16 v[36:39], v[156:159], v[96:99], v[36:39]
    ds_read_b64_tr_b16 v[136:137], v10 offset:25696
    ds_read_b64_tr_b16 v[138:139], v11 offset:25696
    v_mfma_f32_16x16x32_bf16 v[40:43], v[100:103], v[96:99], v[40:43]
    s_waitcnt vmcnt(2) lgkmcnt(12)
    v_mfma_f32_16x16x32_bf16 v[24:27], v[104:107], v[64:67], v[24:27]
    ds_read_b64_tr_b16 v[140:141], v10 offset:25728
    ds_read_b64_tr_b16 v[142:143], v11 offset:25728
    v_mfma_f32_16x16x32_bf16 v[28:31], v[108:111], v[64:67], v[28:31]
    v_mfma_f32_16x16x32_bf16 v[32:35], v[112:115], v[64:67], v[32:35]
    s_waitcnt lgkmcnt(10)
    v_mfma_f32_16x16x32_bf16 v[36:39], v[116:119], v[64:67], v[36:39]
    v_mfma_f32_16x16x32_bf16 v[40:43], v[120:123], v[64:67], v[40:43]
    s_waitcnt vmcnt(0) lgkmcnt(4)
    v_mfma_f32_16x16x32_bf16 v[24:27], v[124:127], v[68:71], v[24:27]
    v_mfma_f32_16x16x32_bf16 v[28:31], v[128:131], v[68:71], v[28:31]
    v_mfma_f32_16x16x32_bf16 v[32:35], v[132:135], v[68:71], v[32:35]
    s_waitcnt lgkmcnt(0)
    v_mfma_f32_16x16x32_bf16 v[36:39], v[136:139], v[68:71], v[36:39]
    v_mfma_f32_16x16x32_bf16 v[40:43], v[140:143], v[68:71], v[40:43]
    s_mul_i32 s54, s63, 160
    s_nop 7
    v_cvt_pk_bf16_f32 v2, v24, v25
    v_cvt_pk_bf16_f32 v3, v26, v27
    ds_write_b64 v17, v[2:3] offset:0
    v_cvt_pk_bf16_f32 v4, v28, v29
    v_cvt_pk_bf16_f32 v5, v30, v31
    ds_write_b64 v17, v[4:5] offset:32
    v_cvt_pk_bf16_f32 v6, v32, v33
    v_cvt_pk_bf16_f32 v7, v34, v35
    ds_write_b64 v17, v[6:7] offset:64
    v_cvt_pk_bf16_f32 v8, v36, v37
    v_cvt_pk_bf16_f32 v9, v38, v39
    ds_write_b64 v17, v[8:9] offset:96
    v_cvt_pk_bf16_f32 v10, v40, v41
    v_cvt_pk_bf16_f32 v11, v42, v43
    ds_write_b64 v17, v[10:11] offset:128
    s_mul_i32 s55, s66, 1280
    s_add_u32 s54, s54, s55
    ds_read_b128 v[44:47], v18 offset:0
    ds_read_b128 v[48:51], v18 offset:1024
    ds_read_b128 v[52:55], v18 offset:2048
    s_waitcnt lgkmcnt(2)
    buffer_store_dwordx4 v[44:47], v13, s[28:31], s54 offen
    s_waitcnt lgkmcnt(1)
    buffer_store_dwordx4 v[48:51], v14, s[28:31], s54 offen
    s_mov_b32 exec_hi, 0
    s_waitcnt lgkmcnt(0)
    buffer_store_dwordx4 v[52:55], v15, s[28:31], s54 offen
    s_endpgm
gated_mix__mha_block__mixer_token_mlp__prompt_kernel_exit:
    s_endpgm
code_end:
.section .rodata,"a"
.p2align 6
.amdhsa_kernel gated_mix__mha_block__mixer_token_mlp__prompt_kernel
  .amdhsa_next_free_vgpr 168
  .amdhsa_next_free_sgpr 102
  .amdhsa_accum_offset 168
  .amdhsa_group_segment_fixed_size 0
  .amdhsa_kernarg_size 96
  .amdhsa_user_sgpr_count 2
  .amdhsa_user_sgpr_kernarg_segment_ptr 1
  .amdhsa_system_sgpr_workgroup_id_x 1
.end_amdhsa_kernel
```
